```python
import torch

def _softmax(x, axis=-1):
    return torch.softmax(x, dim=axis)
def _gelu(x):
    return torch.nn.functional.gelu(x, approximate="tanh")
def _silu(x):
    return torch.nn.functional.silu(x)
def _sigmoid(x):
    return torch.sigmoid(x)
def _layernorm(x, axis=-1, eps=1e-5):
    m = x.mean(dim=axis, keepdim=True)
    v = x.var(dim=axis, keepdim=True, unbiased=False)
    return (x - m) / torch.sqrt(v + eps)
def _scatter_add(tgt, idx, src, axis=0):
    return tgt.clone().index_add_(axis, idx, src)
def _segment_sum(src, seg, n):
    out = torch.zeros((n,) + src.shape[1:], dtype=src.dtype)
    return out.index_add_(0, seg, src)
def _pad(x, pw):
    flat = tuple(v for pair in reversed(pw) for v in pair)
    return torch.nn.functional.pad(x, flat)

kernel_name = 'parallel_sum__mha_block_cached__glu_gated_bilinear__decode'

def setup_inputs():

    _w = (lambda a: (lambda t: t.to(torch.bfloat16) if t.is_floating_point() else t)(torch.as_tensor(a)))
    def _A_setup():
        B, Sq, D = 8, 1, 1024
        H, Sk, Dh = 32, 4096, 128
        return {
            "x": _w((lambda *s: torch.randn(*s, dtype=torch.bfloat16) * 0.05)(B, Sq, D)),
            "k_cache": _w((lambda *s: torch.randn(*s, dtype=torch.bfloat16) * 1.6)(B, H, Sk, Dh)),
            "v_cache": _w((lambda *s: torch.randn(*s, dtype=torch.bfloat16) * 0.8)(B, H, Sk, Dh)),
            "wq": _w((lambda *s: torch.randn(*s, dtype=torch.bfloat16) * 1.6)(D, H * Dh) * (D ** -0.5)),
            "wo": _w((lambda *s: torch.randn(*s, dtype=torch.bfloat16) * 0.8)(H * Dh, D) * ((H * Dh) ** -0.5)),
        }
    _A_in = _A_setup()

    def _B_setup():
        B, S, D, F = 8, 1, 1024, 3584
        return {
            "x": _w((lambda *s: torch.randn(*s, dtype=torch.bfloat16) * 0.05)(B, S, D)),
            "w_gate": _w((lambda *s: torch.randn(*s, dtype=torch.bfloat16) * 0.4)(D, F) * (D ** -0.5)),
            "w_up": _w((lambda *s: torch.randn(*s, dtype=torch.bfloat16) * 0.4)(D, F) * (D ** -0.5)),
            "w_down": _w((lambda *s: torch.randn(*s, dtype=torch.bfloat16) * 0.4)(F, D) * (F ** -0.5)),
        }
    _B_in = _B_setup()

    return {
        "A_x": _A_in["x"],
        "A_k_cache": _A_in["k_cache"],
        "A_v_cache": _A_in["v_cache"],
        "A_wq": _A_in["wq"],
        "A_wo": _A_in["wo"],
        "B_x": _B_in["x"],
        "B_w_gate": _B_in["w_gate"],
        "B_w_up": _B_in["w_up"],
        "B_w_down": _B_in["w_down"],
    }

def reference(A_x, A_k_cache, A_v_cache, A_wq, A_wo, B_x, B_w_gate, B_w_up, B_w_down):
    def _A_ref(x, k_cache, v_cache, wq, wo):
        B, Sq, D = x.shape
        H, Dh = 32, 128
        q = (lambda x, *d: x.permute(*d))((x @ wq).reshape(B, Sq, H, Dh), 0, 2, 1, 3)
        scores = torch.einsum("bhqd,bhkd->bhqk", q, k_cache) * (Dh ** -0.5)
        p = _softmax(scores, axis=-1)
        o = torch.einsum("bhqk,bhkd->bhqd", p, v_cache)
        return (lambda x, *d: x.permute(*d))(o, 0, 2, 1, 3).reshape(B, Sq, H * Dh) @ wo

    def _B_ref(x, w_gate, w_up, w_down):
        g = torch.einsum("bsd,df->bsf", x, w_gate)
        u = torch.einsum("bsd,df->bsf", x, w_up)
        h = g * u
        return torch.einsum("bsf,fd->bsd", h, w_down)

    x = A_x
    xn = _layernorm(x, axis=-1)
    return x + _A_ref(xn, A_k_cache, A_v_cache, A_wq, A_wo) + _B_ref(xn, B_w_gate, B_w_up, B_w_down)
```

```asm
; @launch grid=(256,1,1) block=(640,1,1) lds=155136
.amdgcn_target "amdgcn-amd-amdhsa--gfx950"
.text
.globl parallel_sum__mha_block_cached__glu_gated_bilinear__decode_kernel
.p2align 8
.type parallel_sum__mha_block_cached__glu_gated_bilinear__decode_kernel,@function
parallel_sum__mha_block_cached__glu_gated_bilinear__decode_kernel:
    s_cmp_ge_u32 s2, 256
    s_cbranch_scc1 L_done
    s_load_dwordx16 s[16:31], s[0:1], 0
    s_load_dwordx8 s[32:39], s[0:1], 64
    v_lshrrev_b32 v1, 6, v0
    v_and_b32 v0, 63, v0
    v_readfirstlane_b32 s3, v1
    s_lshr_b32 s4, s2, 5
    s_and_b32 s5, s2, 31
    v_mov_b32 v2, 0
    v_mov_b32 v3, 154176
    v_mov_b32 v4, 1
    s_cmp_ge_u32 s3, 8
    s_cbranch_scc1 L_flow
    s_cmp_ge_u32 s3, 4
    s_cbranch_scc1 L_stream
    s_setprio 3
    s_cmp_lg_u32 s3, 0
    s_cbranch_scc1 L_a_noinit
    v_lshlrev_b32 v5, 2, v0
    v_add_u32 v5, 154176, v5
    v_cmp_gt_u32 vcc, 16, v0
    s_and_saveexec_b64 s[6:7], vcc
    ds_write_b32 v5, v2
    s_mov_b64 exec, s[6:7]
L_a_noinit:
    v_lshrrev_b32 v5, 5, v0
    v_and_b32 v6, 31, v0
    v_lshlrev_b32 v6, 4, v6
    v_lshl_add_u32 v8, v5, 11, v6
    v_lshrrev_b32 v11, 2, v0
    v_mul_u32_u24 v11, 8192, v11
    v_and_b32 v16, 3, v0
    v_lshl_add_u32 v16, v16, 4, v11
    v_lshlrev_b32 v25, 2, v0
    v_mov_b32 v28, -1
    s_lshl_b32 s6, s5, 3
    s_add_u32 s6, s6, s4
    s_xor_b32 s7, s6, 0
    s_lshl_b32 s46, s7, 11
    s_lshl_b32 s47, s7, 9
    s_add_u32 s47, s47, 0x340000
    s_lshl_b32 s48, s2, 12
    s_add_u32 s48, s48, 0x400000
    s_lshl_b32 s49, s6, 8
    s_add_u32 s51, s49, 0x300000
    s_add_u32 s58, s49, 0x320000
    s_add_u32 s57, s47, 256
    s_bitcmp1_b32 s3, 0
    s_cselect_b32 s56, s58, s51
    s_cselect_b32 s57, s57, s47
    s_xor_b32 s56, s56, 0
    s_bitcmp1_b32 s3, 1
    s_cselect_b32 s56, s57, s56
    s_and_b32 s54, s4, 1
    s_lshl_b32 s54, s54, 2
    s_add_u32 s50, s54, s3
    s_lshl_b32 s54, s50, 20
    s_lshl_b32 s7, s5, 8
    s_xor_b32 s7, s7, 0
    s_add_u32 s54, s54, s7
    s_lshr_b32 s7, s4, 1
    s_lshl_b32 s7, s7, 6
    s_add_u32 s54, s54, s7
    s_lshl_b32 s55, s3, 13
    s_lshl_b32 s6, s3, 12
    s_mov_b32 s53, 0x700000
    s_waitcnt lgkmcnt(0)
    s_load_dword s83, s[38:39], s53
    s_mov_b32 s12, s16
    s_mov_b32 s13, s17
    s_mov_b32 s14, 0x4000
    s_mov_b32 s15, 0x20000
    s_mov_b32 s40, s22
    s_mov_b32 s41, s23
    s_mov_b32 s42, 0x800000
    s_mov_b32 s43, 0x20000
    buffer_load_dwordx4 v[32:35], v8, s[12:15], s6 offen offset:0
    buffer_load_dwordx4 v[36:39], v8, s[12:15], s6 offen offset:512
    buffer_load_dwordx4 v[40:43], v8, s[12:15], s6 offen offset:1024
    buffer_load_dwordx4 v[44:47], v8, s[12:15], s6 offen offset:1536
    s_mov_b32 m0, s55
    s_add_u32 s55, s55, 1024
    buffer_load_dwordx4 v16, s[40:43], s54 offen nt lds
    s_add_u32 s54, s54, 131072
    s_mov_b32 m0, s55
    s_add_u32 s55, s55, 1024
    buffer_load_dwordx4 v16, s[40:43], s54 offen nt lds
    s_add_u32 s54, s54, 131072
    s_mov_b32 m0, s55
    s_add_u32 s55, s55, 1024
    buffer_load_dwordx4 v16, s[40:43], s54 offen nt lds
    s_add_u32 s54, s54, 131072
    s_mov_b32 m0, s55
    s_add_u32 s55, s55, 1024
    buffer_load_dwordx4 v16, s[40:43], s54 offen nt lds
    s_add_u32 s54, s54, 131072
    s_mov_b32 m0, s55
    s_add_u32 s55, s55, 1024
    buffer_load_dwordx4 v16, s[40:43], s54 offen nt lds
    s_add_u32 s54, s54, 131072
    s_mov_b32 m0, s55
    s_add_u32 s55, s55, 1024
    buffer_load_dwordx4 v16, s[40:43], s54 offen nt lds
    s_add_u32 s54, s54, 131072
    s_mov_b32 m0, s55
    s_add_u32 s55, s55, 1024
    buffer_load_dwordx4 v16, s[40:43], s54 offen nt lds
    s_add_u32 s54, s54, 131072
    s_mov_b32 m0, s55
    s_add_u32 s55, s55, 1024
    buffer_load_dwordx4 v16, s[40:43], s54 offen nt lds
    s_add_u32 s54, s54, 131072
    s_mov_b32 s8, s38
    s_mov_b32 s9, s39
    s_mov_b32 s10, 0x800000
    s_mov_b32 s11, 0x20000
    buffer_store_dword v28, v25, s[8:11], s56 offen sc1
    s_barrier
    v_and_b32 v9, 15, v0
    v_lshrrev_b32 v11, 4, v0
    v_and_b32 v12, 7, v0
    v_bfe_u32 v13, v0, 3, 1
    v_lshlrev_b32 v13, 6, v13
    v_lshl_add_u32 v13, v11, 4, v13
    v_lshl_add_u32 v10, v12, 7, v13
    v_lshl_add_u32 v24, v12, 9, v13
    s_lshl_b32 s6, s3, 7
    v_add_u32 v24, s6, v24
    v_mul_u32_u24 v58, 2064, v12
    v_lshl_add_u32 v58, v11, 4, v58
    v_add_u32 v58, 131072, v58
    v_mul_u32_u24 v26, 272, v12
    v_lshl_add_u32 v26, v11, 4, v26
    v_add_u32 v26, 147584, v26
    v_lshl_add_u32 v27, v12, 8, v13
    v_lshrrev_b32 v13, 3, v0
    v_lshlrev_b32 v60, 11, v13
    v_lshl_add_u32 v60, v12, 4, v60
    v_lshlrev_b32 v61, 6, v11
    v_lshl_add_u32 v61, v12, 3, v61
    v_add_u32 v61, 149760, v61
    v_lshlrev_b32 v7, 4, v0
    s_lshl_b32 s6, s3, 10
    s_add_u32 s6, s6, 150016
    v_add_u32 v59, s6, v7
    v_bfe_u32 v12, v0, 2, 2
    v_and_b32 v13, 3, v0
    v_lshl_add_u32 v14, v11, 3, v12
    v_lshlrev_b32 v18, 6, v14
    v_lshl_add_u32 v18, v13, 3, v18
    v_lshlrev_b32 v14, 8, v14
    v_lshl_add_u32 v14, v13, 3, v14
    v_and_b32 v15, 1, v11
    v_lshl_or_b32 v15, v15, 2, v12
    s_lshl_b32 s6, s3, 1
    v_xor_b32 v20, s6, v15
    v_xor_b32 v21, 1, v20
    v_lshl_add_u32 v20, v20, 5, v14
    v_lshl_add_u32 v21, v21, 5, v14
    v_cmp_lt_u32 s[44:45], 7, v9
    s_mov_b32 s52, s5
    s_mov_b32 s80, 0xffffff00
    s_mov_b32 s81, 0x0c0c0400
    s_mov_b32 s82, 0x04000c0c
    s_mul_i32 s6, s3, 4128
    s_add_u32 s6, s6, 131072
    v_mul_u32_u24 v57, 2064, v5
    v_add3_u32 v57, v57, v6, s6
    s_mov_b32 s6, 0x3f803f80
    v_mov_b32 v52, 0
    v_mov_b32 v53, 0
    s_waitcnt vmcnt(9)
    v_dot2c_f32_bf16 v52, s6, v32
    v_dot2c_f32_bf16 v53, s6, v33
    v_dot2c_f32_bf16 v52, s6, v34
    v_dot2c_f32_bf16 v53, s6, v35
    v_dot2c_f32_bf16 v52, s6, v36
    v_dot2c_f32_bf16 v53, s6, v37
    v_dot2c_f32_bf16 v52, s6, v38
    v_dot2c_f32_bf16 v53, s6, v39
    v_dot2c_f32_bf16 v52, s6, v40
    v_dot2c_f32_bf16 v53, s6, v41
    v_dot2c_f32_bf16 v52, s6, v42
    v_dot2c_f32_bf16 v53, s6, v43
    v_dot2c_f32_bf16 v52, s6, v44
    v_dot2c_f32_bf16 v53, s6, v45
    v_dot2c_f32_bf16 v52, s6, v46
    v_dot2c_f32_bf16 v53, s6, v47
    v_lshlrev_b32 v96, 16, v32
    v_and_b32 v97, 0xffff0000, v32
    v_lshlrev_b32 v98, 16, v33
    v_and_b32 v99, 0xffff0000, v33
    v_lshlrev_b32 v100, 16, v34
    v_and_b32 v101, 0xffff0000, v34
    v_lshlrev_b32 v102, 16, v35
    v_and_b32 v103, 0xffff0000, v35
    v_lshlrev_b32 v104, 16, v36
    v_and_b32 v105, 0xffff0000, v36
    v_lshlrev_b32 v106, 16, v37
    v_and_b32 v107, 0xffff0000, v37
    v_lshlrev_b32 v108, 16, v38
    v_and_b32 v109, 0xffff0000, v38
    v_lshlrev_b32 v110, 16, v39
    v_and_b32 v111, 0xffff0000, v39
    v_lshlrev_b32 v112, 16, v40
    v_and_b32 v113, 0xffff0000, v40
    v_lshlrev_b32 v114, 16, v41
    v_and_b32 v115, 0xffff0000, v41
    v_lshlrev_b32 v116, 16, v42
    v_and_b32 v117, 0xffff0000, v42
    v_lshlrev_b32 v118, 16, v43
    v_and_b32 v119, 0xffff0000, v43
    v_lshlrev_b32 v120, 16, v44
    v_and_b32 v121, 0xffff0000, v44
    v_lshlrev_b32 v122, 16, v45
    v_and_b32 v123, 0xffff0000, v45
    v_lshlrev_b32 v124, 16, v46
    v_and_b32 v125, 0xffff0000, v46
    v_lshlrev_b32 v126, 16, v47
    v_and_b32 v127, 0xffff0000, v47
    v_add_f32 v52, v52, v53
    s_nop 1
    v_add_f32_dpp v52, v52, v52 row_ror:8 row_mask:0xf bank_mask:0xf
    s_nop 1
    v_add_f32_dpp v52, v52, v52 row_ror:4 row_mask:0xf bank_mask:0xf
    s_nop 1
    v_add_f32_dpp v52, v52, v52 row_ror:2 row_mask:0xf bank_mask:0xf
    s_nop 1
    v_add_f32_dpp v52, v52, v52 row_ror:1 row_mask:0xf bank_mask:0xf
    v_mov_b32 v53, v52
    s_nop 1
    v_permlane16_swap_b32 v52, v53
    s_nop 1
    v_add_f32 v52, v52, v53
    v_mul_f32 v52, 0x3a800000, v52
    v_mov_b32 v54, 0
    v_mov_b32 v55, 0
    v_pk_add_f32 v[48:49], v[96:97], v[52:53] op_sel_hi:[1,0] neg_lo:[0,1] neg_hi:[0,1]
    v_pk_fma_f32 v[54:55], v[48:49], v[48:49], v[54:55]
    v_pk_add_f32 v[50:51], v[98:99], v[52:53] op_sel_hi:[1,0] neg_lo:[0,1] neg_hi:[0,1]
    v_pk_fma_f32 v[54:55], v[50:51], v[50:51], v[54:55]
    v_pk_add_f32 v[48:49], v[100:101], v[52:53] op_sel_hi:[1,0] neg_lo:[0,1] neg_hi:[0,1]
    v_pk_fma_f32 v[54:55], v[48:49], v[48:49], v[54:55]
    v_pk_add_f32 v[50:51], v[102:103], v[52:53] op_sel_hi:[1,0] neg_lo:[0,1] neg_hi:[0,1]
    v_pk_fma_f32 v[54:55], v[50:51], v[50:51], v[54:55]
    v_pk_add_f32 v[48:49], v[104:105], v[52:53] op_sel_hi:[1,0] neg_lo:[0,1] neg_hi:[0,1]
    v_pk_fma_f32 v[54:55], v[48:49], v[48:49], v[54:55]
    v_pk_add_f32 v[50:51], v[106:107], v[52:53] op_sel_hi:[1,0] neg_lo:[0,1] neg_hi:[0,1]
    v_pk_fma_f32 v[54:55], v[50:51], v[50:51], v[54:55]
    v_pk_add_f32 v[48:49], v[108:109], v[52:53] op_sel_hi:[1,0] neg_lo:[0,1] neg_hi:[0,1]
    v_pk_fma_f32 v[54:55], v[48:49], v[48:49], v[54:55]
    v_pk_add_f32 v[50:51], v[110:111], v[52:53] op_sel_hi:[1,0] neg_lo:[0,1] neg_hi:[0,1]
    v_pk_fma_f32 v[54:55], v[50:51], v[50:51], v[54:55]
    v_pk_add_f32 v[48:49], v[112:113], v[52:53] op_sel_hi:[1,0] neg_lo:[0,1] neg_hi:[0,1]
    v_pk_fma_f32 v[54:55], v[48:49], v[48:49], v[54:55]
    v_pk_add_f32 v[50:51], v[114:115], v[52:53] op_sel_hi:[1,0] neg_lo:[0,1] neg_hi:[0,1]
    v_pk_fma_f32 v[54:55], v[50:51], v[50:51], v[54:55]
    v_pk_add_f32 v[48:49], v[116:117], v[52:53] op_sel_hi:[1,0] neg_lo:[0,1] neg_hi:[0,1]
    v_pk_fma_f32 v[54:55], v[48:49], v[48:49], v[54:55]
    v_pk_add_f32 v[50:51], v[118:119], v[52:53] op_sel_hi:[1,0] neg_lo:[0,1] neg_hi:[0,1]
    v_pk_fma_f32 v[54:55], v[50:51], v[50:51], v[54:55]
    v_pk_add_f32 v[48:49], v[120:121], v[52:53] op_sel_hi:[1,0] neg_lo:[0,1] neg_hi:[0,1]
    v_pk_fma_f32 v[54:55], v[48:49], v[48:49], v[54:55]
    v_pk_add_f32 v[50:51], v[122:123], v[52:53] op_sel_hi:[1,0] neg_lo:[0,1] neg_hi:[0,1]
    v_pk_fma_f32 v[54:55], v[50:51], v[50:51], v[54:55]
    v_pk_add_f32 v[48:49], v[124:125], v[52:53] op_sel_hi:[1,0] neg_lo:[0,1] neg_hi:[0,1]
    v_pk_fma_f32 v[54:55], v[48:49], v[48:49], v[54:55]
    v_pk_add_f32 v[50:51], v[126:127], v[52:53] op_sel_hi:[1,0] neg_lo:[0,1] neg_hi:[0,1]
    v_pk_fma_f32 v[54:55], v[50:51], v[50:51], v[54:55]
    v_add_f32 v54, v54, v55
    s_nop 1
    v_add_f32_dpp v54, v54, v54 row_ror:8 row_mask:0xf bank_mask:0xf
    s_nop 1
    v_add_f32_dpp v54, v54, v54 row_ror:4 row_mask:0xf bank_mask:0xf
    s_nop 1
    v_add_f32_dpp v54, v54, v54 row_ror:2 row_mask:0xf bank_mask:0xf
    s_nop 1
    v_add_f32_dpp v54, v54, v54 row_ror:1 row_mask:0xf bank_mask:0xf
    v_mov_b32 v55, v54
    s_nop 1
    v_permlane16_swap_b32 v54, v55
    s_nop 1
    v_add_f32 v54, v54, v55
    v_mul_f32 v54, 0x3a800000, v54
    v_cvt_pk_bf16_f32 v52, 0, v52
    v_cvt_pk_bf16_f32 v54, 0, v54
    v_add_f32 v54, 0x3727c5ac, v54
    v_cvt_pk_bf16_f32 v54, 0, v54
    v_sqrt_f32 v54, v54
    s_nop 0
    v_cvt_pk_bf16_f32 v54, 0, v54
    v_rcp_f32 v54, v54
    v_pk_add_f32 v[96:97], v[96:97], v[52:53] op_sel_hi:[1,0] neg_lo:[0,1] neg_hi:[0,1]
    v_pk_add_f32 v[98:99], v[98:99], v[52:53] op_sel_hi:[1,0] neg_lo:[0,1] neg_hi:[0,1]
    v_pk_add_f32 v[100:101], v[100:101], v[52:53] op_sel_hi:[1,0] neg_lo:[0,1] neg_hi:[0,1]
    v_pk_add_f32 v[102:103], v[102:103], v[52:53] op_sel_hi:[1,0] neg_lo:[0,1] neg_hi:[0,1]
    v_pk_add_f32 v[104:105], v[104:105], v[52:53] op_sel_hi:[1,0] neg_lo:[0,1] neg_hi:[0,1]
    v_pk_add_f32 v[106:107], v[106:107], v[52:53] op_sel_hi:[1,0] neg_lo:[0,1] neg_hi:[0,1]
    v_pk_add_f32 v[108:109], v[108:109], v[52:53] op_sel_hi:[1,0] neg_lo:[0,1] neg_hi:[0,1]
    v_pk_add_f32 v[110:111], v[110:111], v[52:53] op_sel_hi:[1,0] neg_lo:[0,1] neg_hi:[0,1]
    v_pk_add_f32 v[112:113], v[112:113], v[52:53] op_sel_hi:[1,0] neg_lo:[0,1] neg_hi:[0,1]
    v_pk_add_f32 v[114:115], v[114:115], v[52:53] op_sel_hi:[1,0] neg_lo:[0,1] neg_hi:[0,1]
    v_pk_add_f32 v[116:117], v[116:117], v[52:53] op_sel_hi:[1,0] neg_lo:[0,1] neg_hi:[0,1]
    v_pk_add_f32 v[118:119], v[118:119], v[52:53] op_sel_hi:[1,0] neg_lo:[0,1] neg_hi:[0,1]
    v_pk_add_f32 v[120:121], v[120:121], v[52:53] op_sel_hi:[1,0] neg_lo:[0,1] neg_hi:[0,1]
    v_pk_add_f32 v[122:123], v[122:123], v[52:53] op_sel_hi:[1,0] neg_lo:[0,1] neg_hi:[0,1]
    v_pk_add_f32 v[124:125], v[124:125], v[52:53] op_sel_hi:[1,0] neg_lo:[0,1] neg_hi:[0,1]
    v_pk_add_f32 v[126:127], v[126:127], v[52:53] op_sel_hi:[1,0] neg_lo:[0,1] neg_hi:[0,1]
    v_cvt_pk_bf16_f32 v96, 0, v96
    v_cvt_pk_bf16_f32 v97, 0, v97
    v_cvt_pk_bf16_f32 v98, 0, v98
    v_cvt_pk_bf16_f32 v99, 0, v99
    v_cvt_pk_bf16_f32 v100, 0, v100
    v_cvt_pk_bf16_f32 v101, 0, v101
    v_cvt_pk_bf16_f32 v102, 0, v102
    v_cvt_pk_bf16_f32 v103, 0, v103
    v_cvt_pk_bf16_f32 v104, 0, v104
    v_cvt_pk_bf16_f32 v105, 0, v105
    v_cvt_pk_bf16_f32 v106, 0, v106
    v_cvt_pk_bf16_f32 v107, 0, v107
    v_cvt_pk_bf16_f32 v108, 0, v108
    v_cvt_pk_bf16_f32 v109, 0, v109
    v_cvt_pk_bf16_f32 v110, 0, v110
    v_cvt_pk_bf16_f32 v111, 0, v111
    v_cvt_pk_bf16_f32 v112, 0, v112
    v_cvt_pk_bf16_f32 v113, 0, v113
    v_cvt_pk_bf16_f32 v114, 0, v114
    v_cvt_pk_bf16_f32 v115, 0, v115
    v_cvt_pk_bf16_f32 v116, 0, v116
    v_cvt_pk_bf16_f32 v117, 0, v117
    v_cvt_pk_bf16_f32 v118, 0, v118
    v_cvt_pk_bf16_f32 v119, 0, v119
    v_cvt_pk_bf16_f32 v120, 0, v120
    v_cvt_pk_bf16_f32 v121, 0, v121
    v_cvt_pk_bf16_f32 v122, 0, v122
    v_cvt_pk_bf16_f32 v123, 0, v123
    v_cvt_pk_bf16_f32 v124, 0, v124
    v_cvt_pk_bf16_f32 v125, 0, v125
    v_cvt_pk_bf16_f32 v126, 0, v126
    v_cvt_pk_bf16_f32 v127, 0, v127
    v_pk_mul_f32 v[96:97], v[96:97], v[54:55] op_sel_hi:[1,0]
    v_pk_mul_f32 v[98:99], v[98:99], v[54:55] op_sel_hi:[1,0]
    v_pk_mul_f32 v[100:101], v[100:101], v[54:55] op_sel_hi:[1,0]
    v_pk_mul_f32 v[102:103], v[102:103], v[54:55] op_sel_hi:[1,0]
    v_pk_mul_f32 v[104:105], v[104:105], v[54:55] op_sel_hi:[1,0]
    v_pk_mul_f32 v[106:107], v[106:107], v[54:55] op_sel_hi:[1,0]
    v_pk_mul_f32 v[108:109], v[108:109], v[54:55] op_sel_hi:[1,0]
    v_pk_mul_f32 v[110:111], v[110:111], v[54:55] op_sel_hi:[1,0]
    v_pk_mul_f32 v[112:113], v[112:113], v[54:55] op_sel_hi:[1,0]
    v_pk_mul_f32 v[114:115], v[114:115], v[54:55] op_sel_hi:[1,0]
    v_pk_mul_f32 v[116:117], v[116:117], v[54:55] op_sel_hi:[1,0]
    v_pk_mul_f32 v[118:119], v[118:119], v[54:55] op_sel_hi:[1,0]
    v_pk_mul_f32 v[120:121], v[120:121], v[54:55] op_sel_hi:[1,0]
    v_pk_mul_f32 v[122:123], v[122:123], v[54:55] op_sel_hi:[1,0]
    v_pk_mul_f32 v[124:125], v[124:125], v[54:55] op_sel_hi:[1,0]
    v_pk_mul_f32 v[126:127], v[126:127], v[54:55] op_sel_hi:[1,0]
    v_cvt_pk_bf16_f32 v32, v96, v97
    v_cvt_pk_bf16_f32 v33, v98, v99
    v_cvt_pk_bf16_f32 v34, v100, v101
    v_cvt_pk_bf16_f32 v35, v102, v103
    ds_write_b128 v57, v[32:35] offset:0
    v_cvt_pk_bf16_f32 v36, v104, v105
    v_cvt_pk_bf16_f32 v37, v106, v107
    v_cvt_pk_bf16_f32 v38, v108, v109
    v_cvt_pk_bf16_f32 v39, v110, v111
    ds_write_b128 v57, v[36:39] offset:512
    v_cvt_pk_bf16_f32 v40, v112, v113
    v_cvt_pk_bf16_f32 v41, v114, v115
    v_cvt_pk_bf16_f32 v42, v116, v117
    v_cvt_pk_bf16_f32 v43, v118, v119
    ds_write_b128 v57, v[40:43] offset:1024
    v_cvt_pk_bf16_f32 v44, v120, v121
    v_cvt_pk_bf16_f32 v45, v122, v123
    v_cvt_pk_bf16_f32 v46, v124, v125
    v_cvt_pk_bf16_f32 v47, v126, v127
    ds_write_b128 v57, v[44:47] offset:1536
    s_waitcnt lgkmcnt(0)
    s_mov_b64 s[6:7], exec
    s_mov_b64 exec, 1
    ds_add_u32 v3, v4 offset:0
    s_mov_b64 exec, s[6:7]
    s_add_u32 s83, s83, 0x9e3779b9
    s_bitset0_b32 s83, 0
    v_mov_b32 v19, s83
    v_bfe_u32 v12, v19, 0, 8
    v_bfe_u32 v13, v19, 8, 8
    v_bfe_u32 v14, v19, 16, 8
    v_bfe_u32 v15, v19, 24, 8
    v_mov_b32 v33, s83
    v_mov_b32 v35, s83
    v_mov_b32 v37, s83
    v_mov_b32 v39, s83
    s_lshl_b32 s6, s50, 8
    v_add_u32 v22, s6, v58
    s_lshl_b32 s6, s3, 13
    v_add_u32 v23, s6, v18
Lw_1:
    ds_read_b32 v56, v3 offset:0
    s_waitcnt lgkmcnt(0)
    v_readfirstlane_b32 s6, v56
    s_nop 0
    s_cmp_ge_u32 s6, 4
    s_cbranch_scc1 Lwd_2
    s_sleep 0
    s_branch Lw_1
Lwd_2:
    ds_read_b128 v[64:67], v22 offset:0
    ds_read_b128 v[68:71], v22 offset:64
    ds_read_b128 v[72:75], v22 offset:128
    ds_read_b128 v[76:79], v22 offset:192
    s_waitcnt vmcnt(1)
    ds_read_b64_tr_b16 v[96:97], v23 offset:0
    ds_read_b64_tr_b16 v[98:99], v23 offset:256
    ds_read_b64_tr_b16 v[112:113], v23 offset:32
    ds_read_b64_tr_b16 v[114:115], v23 offset:288
    ds_read_b64_tr_b16 v[100:101], v23 offset:2048
    ds_read_b64_tr_b16 v[102:103], v23 offset:2304
    ds_read_b64_tr_b16 v[116:117], v23 offset:2080
    ds_read_b64_tr_b16 v[118:119], v23 offset:2336
    ds_read_b64_tr_b16 v[104:105], v23 offset:4096
    ds_read_b64_tr_b16 v[106:107], v23 offset:4352
    ds_read_b64_tr_b16 v[120:121], v23 offset:4128
    ds_read_b64_tr_b16 v[122:123], v23 offset:4384
    ds_read_b64_tr_b16 v[108:109], v23 offset:6144
    ds_read_b64_tr_b16 v[110:111], v23 offset:6400
    ds_read_b64_tr_b16 v[124:125], v23 offset:6176
    ds_read_b64_tr_b16 v[126:127], v23 offset:6432
    s_waitcnt lgkmcnt(0)
    v_mfma_f32_16x16x32_bf16 v[80:83], v[96:99], v[64:67], 0
    v_mfma_f32_16x16x32_bf16 v[84:87], v[112:115], v[64:67], 0
    v_mfma_f32_16x16x32_bf16 v[80:83], v[100:103], v[68:71], v[80:83]
    v_mfma_f32_16x16x32_bf16 v[84:87], v[116:119], v[68:71], v[84:87]
    v_mfma_f32_16x16x32_bf16 v[80:83], v[104:107], v[72:75], v[80:83]
    v_mfma_f32_16x16x32_bf16 v[84:87], v[120:123], v[72:75], v[84:87]
    v_mfma_f32_16x16x32_bf16 v[80:83], v[108:111], v[76:79], v[80:83]
    v_mfma_f32_16x16x32_bf16 v[84:87], v[124:127], v[76:79], v[84:87]
    s_nop 7
    v_cndmask_b32 v28, v80, v84, s[44:45]
    v_cndmask_b32 v29, v81, v85, s[44:45]
    v_cndmask_b32 v30, v82, v86, s[44:45]
    v_cndmask_b32 v31, v83, v87, s[44:45]
    s_cmp_eq_u32 s3, 0
    s_cbranch_scc1 Lr_3
    ds_write_b128 v59, v[28:31]
    s_waitcnt vmcnt(0) lgkmcnt(0)
    s_mov_b64 s[6:7], exec
    s_mov_b64 exec, 1
    ds_add_u32 v3, v4 offset:28
    s_mov_b64 exec, s[6:7]
    s_branch L_a123
Lr_3:
Lw_4:
    ds_read_b32 v56, v3 offset:28
    s_waitcnt lgkmcnt(0)
    v_readfirstlane_b32 s6, v56
    s_nop 0
    s_cmp_ge_u32 s6, 3
    s_cbranch_scc1 Lwd_5
    s_sleep 0
    s_branch Lw_4
Lwd_5:
    ds_read_b128 v[132:135], v59 offset:1024
    ds_read_b128 v[136:139], v59 offset:2048
    ds_read_b128 v[140:143], v59 offset:3072
    s_waitcnt lgkmcnt(1)
    v_add_f32 v28, v28, v132
    v_add_f32 v29, v29, v133
    v_add_f32 v30, v30, v134
    v_add_f32 v31, v31, v135
    s_waitcnt lgkmcnt(0)
    v_add_f32 v136, v136, v140
    v_add_f32 v137, v137, v141
    v_add_f32 v138, v138, v142
    v_add_f32 v139, v139, v143
    v_add_f32 v32, v28, v136
    v_add_f32 v34, v29, v137
    v_add_f32 v36, v30, v138
    v_add_f32 v38, v31, v139
    s_waitcnt vmcnt(0)
    buffer_store_dwordx4 v[32:35], v10, s[8:11], s46 offen sc1
    buffer_store_dwordx4 v[36:39], v10, s[8:11], s46 offen offset:1024 sc1
    s_lshl_b32 s60, s5, 14
    s_lshl_b32 s6, s4, 7
    s_add_u32 s60, s60, s6
    s_waitcnt vmcnt(0)
    s_mov_b32 s53, 20000
    buffer_load_dwordx4 v[128:131], v60, s[8:11], s60 offen offset:0 sc1
    buffer_load_dwordx4 v[132:135], v60, s[8:11], s60 offen offset:1024 sc1
Lp_6:
    s_waitcnt vmcnt(0)
    v_xor_b32 v57, v129, v19
    v_xor_b32 v56, v131, v19
    v_or_b32 v57, v57, v56
    v_cmp_ne_u32 s[72:73], 0, v57
    v_xor_b32 v57, v133, v19
    v_xor_b32 v56, v135, v19
    v_or_b32 v57, v57, v56
    v_cmp_ne_u32 s[74:75], 0, v57
    s_or_b64 vcc, s[72:73], s[74:75]
    s_cbranch_scc0 Lpd_7
    s_sub_u32 s53, s53, 1
    s_cbranch_scc1 Lpd_7
    s_wqm_b64 exec, s[72:73]
    s_cbranch_execz Lps_8
    buffer_load_dwordx4 v[128:131], v60, s[8:11], s60 offen offset:0 sc1
Lps_8:
    s_wqm_b64 exec, s[74:75]
    s_cbranch_execz Lps_9
    buffer_load_dwordx4 v[132:135], v60, s[8:11], s60 offen offset:1024 sc1
Lps_9:
    s_mov_b64 exec, -1
    s_branch Lp_6
Lpd_7:
    v_add_f32_dpp v128, v128, v128 row_ror:8 row_mask:0xf bank_mask:0xf
    v_add_f32_dpp v130, v130, v130 row_ror:8 row_mask:0xf bank_mask:0xf
    v_add_f32_dpp v132, v132, v132 row_ror:8 row_mask:0xf bank_mask:0xf
    v_add_f32_dpp v134, v134, v134 row_ror:8 row_mask:0xf bank_mask:0xf
    v_cvt_pk_bf16_f32 v128, v128, v130
    v_cvt_pk_bf16_f32 v129, v132, v134
    ds_write_b64 v61, v[128:129]
    s_mov_b64 exec, 1
    ds_add_u32 v3, v4 offset:4
    s_mov_b64 exec, -1
    s_mov_b32 s40, s24
    s_mov_b32 s41, s25
    s_mov_b32 s42, 0x800000
    s_mov_b32 s43, 0x20000
    s_mov_b32 s7, 0
    s_mov_b32 s59, s5
    s_branch L_a03_dma
L_a123:
    s_cmp_ge_u32 s52, 28
    s_cbranch_scc1 L_a_bar2
Lw_10:
    ds_read_b32 v56, v3 offset:12
    s_waitcnt lgkmcnt(0)
    v_readfirstlane_b32 s6, v56
    s_nop 0
    s_cmp_ge_u32 s6, 4
    s_cbranch_scc1 Lwd_11
    s_sleep 2
    s_branch Lw_10
Lwd_11:
    s_cmp_eq_u32 s3, 3
    s_cbranch_scc1 L_a3_dma
    v_lshrrev_b32 v56, 2, v0
    v_mul_u32_u24 v56, 7168, v56
    v_and_b32 v16, 3, v0
    v_lshl_add_u32 v16, v16, 4, v56
    s_cmp_lt_u32 s4, 4
    s_cselect_b32 s40, s28, s30
    s_cselect_b32 s41, s29, s31
    s_lshl_b32 s7, s3, 15
    s_mov_b32 s42, 0x700000
    s_mov_b32 s43, 0x20000
    s_sub_u32 s6, s3, 1
    s_mul_i32 s6, s6, 3670016
    s_lshl_b32 s53, s52, 8
    s_xor_b32 s53, s53, 0
    s_add_u32 s6, s6, s53
    s_and_b32 s53, s4, 3
    s_lshl_b32 s53, s53, 6
    s_add_u32 s6, s6, s53
    s_mov_b32 m0, s7
    s_add_u32 s7, s7, 1024
    buffer_load_dwordx4 v16, s[40:43], s6 offen nt lds
    s_add_u32 s6, s6, 114688
    s_mov_b32 m0, s7
    s_add_u32 s7, s7, 1024
    buffer_load_dwordx4 v16, s[40:43], s6 offen nt lds
    s_add_u32 s6, s6, 114688
    s_mov_b32 m0, s7
    s_add_u32 s7, s7, 1024
    buffer_load_dwordx4 v16, s[40:43], s6 offen nt lds
    s_add_u32 s6, s6, 114688
    s_mov_b32 m0, s7
    s_add_u32 s7, s7, 1024
    buffer_load_dwordx4 v16, s[40:43], s6 offen nt lds
    s_add_u32 s6, s6, 114688
    s_mov_b32 m0, s7
    s_add_u32 s7, s7, 1024
    buffer_load_dwordx4 v16, s[40:43], s6 offen nt lds
    s_add_u32 s6, s6, 114688
    s_mov_b32 m0, s7
    s_add_u32 s7, s7, 1024
    buffer_load_dwordx4 v16, s[40:43], s6 offen nt lds
    s_add_u32 s6, s6, 114688
    s_mov_b32 m0, s7
    s_add_u32 s7, s7, 1024
    buffer_load_dwordx4 v16, s[40:43], s6 offen nt lds
    s_add_u32 s6, s6, 114688
    s_mov_b32 m0, s7
    s_add_u32 s7, s7, 1024
    buffer_load_dwordx4 v16, s[40:43], s6 offen nt lds
    s_add_u32 s6, s6, 114688
    s_mov_b32 m0, s7
    s_add_u32 s7, s7, 1024
    buffer_load_dwordx4 v16, s[40:43], s6 offen nt lds
    s_add_u32 s6, s6, 114688
    s_mov_b32 m0, s7
    s_add_u32 s7, s7, 1024
    buffer_load_dwordx4 v16, s[40:43], s6 offen nt lds
    s_add_u32 s6, s6, 114688
    s_mov_b32 m0, s7
    s_add_u32 s7, s7, 1024
    buffer_load_dwordx4 v16, s[40:43], s6 offen nt lds
    s_add_u32 s6, s6, 114688
    s_mov_b32 m0, s7
    s_add_u32 s7, s7, 1024
    buffer_load_dwordx4 v16, s[40:43], s6 offen nt lds
    s_add_u32 s6, s6, 114688
    s_waitcnt vmcnt(11)
    s_mov_b32 m0, s7
    s_add_u32 s7, s7, 1024
    buffer_load_dwordx4 v16, s[40:43], s6 offen nt lds
    s_add_u32 s6, s6, 114688
    s_waitcnt vmcnt(11)
    s_mov_b32 m0, s7
    s_add_u32 s7, s7, 1024
    buffer_load_dwordx4 v16, s[40:43], s6 offen nt lds
    s_add_u32 s6, s6, 114688
    s_waitcnt vmcnt(11)
    s_mov_b32 m0, s7
    s_add_u32 s7, s7, 1024
    buffer_load_dwordx4 v16, s[40:43], s6 offen nt lds
    s_add_u32 s6, s6, 114688
    s_waitcnt vmcnt(11)
    s_mov_b32 m0, s7
    s_add_u32 s7, s7, 1024
    buffer_load_dwordx4 v16, s[40:43], s6 offen nt lds
    s_add_u32 s6, s6, 114688
    s_waitcnt vmcnt(11)
    s_mov_b32 m0, s7
    s_add_u32 s7, s7, 1024
    buffer_load_dwordx4 v16, s[40:43], s6 offen nt lds
    s_add_u32 s6, s6, 114688
    s_waitcnt vmcnt(11)
    s_mov_b32 m0, s7
    s_add_u32 s7, s7, 1024
    buffer_load_dwordx4 v16, s[40:43], s6 offen nt lds
    s_add_u32 s6, s6, 114688
    s_waitcnt vmcnt(11)
    s_mov_b32 m0, s7
    s_add_u32 s7, s7, 1024
    buffer_load_dwordx4 v16, s[40:43], s6 offen nt lds
    s_add_u32 s6, s6, 114688
    s_waitcnt vmcnt(11)
    s_mov_b32 m0, s7
    s_add_u32 s7, s7, 1024
    buffer_load_dwordx4 v16, s[40:43], s6 offen nt lds
    s_add_u32 s6, s6, 114688
    s_waitcnt vmcnt(11)
    s_mov_b32 m0, s7
    s_add_u32 s7, s7, 1024
    buffer_load_dwordx4 v16, s[40:43], s6 offen nt lds
    s_add_u32 s6, s6, 114688
    s_waitcnt vmcnt(11)
    s_mov_b32 m0, s7
    s_add_u32 s7, s7, 1024
    buffer_load_dwordx4 v16, s[40:43], s6 offen nt lds
    s_add_u32 s6, s6, 114688
    s_waitcnt vmcnt(11)
    s_mov_b32 m0, s7
    s_add_u32 s7, s7, 1024
    buffer_load_dwordx4 v16, s[40:43], s6 offen nt lds
    s_add_u32 s6, s6, 114688
    s_waitcnt vmcnt(11)
    s_mov_b32 m0, s7
    s_add_u32 s7, s7, 1024
    buffer_load_dwordx4 v16, s[40:43], s6 offen nt lds
    s_add_u32 s6, s6, 114688
    s_waitcnt vmcnt(11)
    s_mov_b32 m0, s7
    s_add_u32 s7, s7, 1024
    buffer_load_dwordx4 v16, s[40:43], s6 offen nt lds
    s_add_u32 s6, s6, 114688
    s_waitcnt vmcnt(11)
    s_mov_b32 m0, s7
    s_add_u32 s7, s7, 1024
    buffer_load_dwordx4 v16, s[40:43], s6 offen nt lds
    s_add_u32 s6, s6, 114688
    s_waitcnt vmcnt(11)
    s_mov_b32 m0, s7
    s_add_u32 s7, s7, 1024
    buffer_load_dwordx4 v16, s[40:43], s6 offen nt lds
    s_add_u32 s6, s6, 114688
    s_waitcnt vmcnt(11)
    s_mov_b32 m0, s7
    s_add_u32 s7, s7, 1024
    buffer_load_dwordx4 v16, s[40:43], s6 offen nt lds
    s_add_u32 s6, s6, 114688
    s_waitcnt vmcnt(11)
    s_mov_b32 m0, s7
    s_add_u32 s7, s7, 1024
    buffer_load_dwordx4 v16, s[40:43], s6 offen nt lds
    s_add_u32 s6, s6, 114688
    s_waitcnt vmcnt(11)
    s_mov_b32 m0, s7
    s_add_u32 s7, s7, 1024
    buffer_load_dwordx4 v16, s[40:43], s6 offen nt lds
    s_add_u32 s6, s6, 114688
    s_waitcnt vmcnt(11)
    s_mov_b32 m0, s7
    s_add_u32 s7, s7, 1024
    buffer_load_dwordx4 v16, s[40:43], s6 offen nt lds
    s_add_u32 s6, s6, 114688
    s_waitcnt vmcnt(11)
    s_mov_b32 m0, s7
    s_add_u32 s7, s7, 1024
    buffer_load_dwordx4 v16, s[40:43], s6 offen nt lds
    s_add_u32 s6, s6, 114688
    s_branch L_a_bar2
L_a3_dma:
    s_mov_b32 s40, s32
    s_mov_b32 s41, s33
    s_mov_b32 s42, 0x700000
    s_mov_b32 s43, 0x20000
    s_mov_b32 s7, 98304
    s_mov_b32 s59, s52
L_a03_dma:
    v_lshrrev_b32 v56, 4, v0
    v_and_b32 v57, 15, v0
    v_lshlrev_b32 v16, 1, v56
    v_xor_b32 v16, v16, v57
    v_lshlrev_b32 v16, 4, v16
    s_mov_b32 s6, 2048
    v_mul_lo_u32 v56, v56, s6
    v_add_u32 v16, v16, v56
    v_xor_b32 v17, 128, v16
    s_lshl_b32 s6, s59, 18
    s_lshl_b32 s53, s4, 8
    s_add_u32 s6, s6, s53
    s_mov_b32 m0, s7
    s_add_u32 s7, s7, 1024
    buffer_load_dwordx4 v16, s[40:43], s6 offen nt lds
    s_add_u32 s6, s6, 8192
    s_mov_b32 m0, s7
    s_add_u32 s7, s7, 1024
    buffer_load_dwordx4 v16, s[40:43], s6 offen nt lds
    s_add_u32 s6, s6, 8192
    s_mov_b32 m0, s7
    s_add_u32 s7, s7, 1024
    buffer_load_dwordx4 v17, s[40:43], s6 offen nt lds
    s_add_u32 s6, s6, 8192
    s_mov_b32 m0, s7
    s_add_u32 s7, s7, 1024
    buffer_load_dwordx4 v17, s[40:43], s6 offen nt lds
    s_add_u32 s6, s6, 8192
    s_mov_b32 m0, s7
    s_add_u32 s7, s7, 1024
    buffer_load_dwordx4 v16, s[40:43], s6 offen nt lds
    s_add_u32 s6, s6, 8192
    s_mov_b32 m0, s7
    s_add_u32 s7, s7, 1024
    buffer_load_dwordx4 v16, s[40:43], s6 offen nt lds
    s_add_u32 s6, s6, 8192
    s_mov_b32 m0, s7
    s_add_u32 s7, s7, 1024
    buffer_load_dwordx4 v17, s[40:43], s6 offen nt lds
    s_add_u32 s6, s6, 8192
    s_mov_b32 m0, s7
    s_add_u32 s7, s7, 1024
    buffer_load_dwordx4 v17, s[40:43], s6 offen nt lds
    s_add_u32 s6, s6, 8192
    s_mov_b32 m0, s7
    s_add_u32 s7, s7, 1024
    buffer_load_dwordx4 v16, s[40:43], s6 offen nt lds
    s_add_u32 s6, s6, 8192
    s_mov_b32 m0, s7
    s_add_u32 s7, s7, 1024
    buffer_load_dwordx4 v16, s[40:43], s6 offen nt lds
    s_add_u32 s6, s6, 8192
    s_mov_b32 m0, s7
    s_add_u32 s7, s7, 1024
    buffer_load_dwordx4 v17, s[40:43], s6 offen nt lds
    s_add_u32 s6, s6, 8192
    s_mov_b32 m0, s7
    s_add_u32 s7, s7, 1024
    buffer_load_dwordx4 v17, s[40:43], s6 offen nt lds
    s_add_u32 s6, s6, 8192
    s_waitcnt vmcnt(11)
    s_mov_b32 m0, s7
    s_add_u32 s7, s7, 1024
    buffer_load_dwordx4 v16, s[40:43], s6 offen nt lds
    s_add_u32 s6, s6, 8192
    s_waitcnt vmcnt(11)
    s_mov_b32 m0, s7
    s_add_u32 s7, s7, 1024
    buffer_load_dwordx4 v16, s[40:43], s6 offen nt lds
    s_add_u32 s6, s6, 8192
    s_waitcnt vmcnt(11)
    s_mov_b32 m0, s7
    s_add_u32 s7, s7, 1024
    buffer_load_dwordx4 v17, s[40:43], s6 offen nt lds
    s_add_u32 s6, s6, 8192
    s_waitcnt vmcnt(11)
    s_mov_b32 m0, s7
    s_add_u32 s7, s7, 1024
    buffer_load_dwordx4 v17, s[40:43], s6 offen nt lds
    s_add_u32 s6, s6, 8192
    s_waitcnt vmcnt(11)
    s_mov_b32 m0, s7
    s_add_u32 s7, s7, 1024
    buffer_load_dwordx4 v16, s[40:43], s6 offen nt lds
    s_add_u32 s6, s6, 8192
    s_waitcnt vmcnt(11)
    s_mov_b32 m0, s7
    s_add_u32 s7, s7, 1024
    buffer_load_dwordx4 v16, s[40:43], s6 offen nt lds
    s_add_u32 s6, s6, 8192
    s_waitcnt vmcnt(11)
    s_mov_b32 m0, s7
    s_add_u32 s7, s7, 1024
    buffer_load_dwordx4 v17, s[40:43], s6 offen nt lds
    s_add_u32 s6, s6, 8192
    s_waitcnt vmcnt(11)
    s_mov_b32 m0, s7
    s_add_u32 s7, s7, 1024
    buffer_load_dwordx4 v17, s[40:43], s6 offen nt lds
    s_add_u32 s6, s6, 8192
    s_waitcnt vmcnt(11)
    s_mov_b32 m0, s7
    s_add_u32 s7, s7, 1024
    buffer_load_dwordx4 v16, s[40:43], s6 offen nt lds
    s_add_u32 s6, s6, 8192
    s_waitcnt vmcnt(11)
    s_mov_b32 m0, s7
    s_add_u32 s7, s7, 1024
    buffer_load_dwordx4 v16, s[40:43], s6 offen nt lds
    s_add_u32 s6, s6, 8192
    s_waitcnt vmcnt(11)
    s_mov_b32 m0, s7
    s_add_u32 s7, s7, 1024
    buffer_load_dwordx4 v17, s[40:43], s6 offen nt lds
    s_add_u32 s6, s6, 8192
    s_waitcnt vmcnt(11)
    s_mov_b32 m0, s7
    s_add_u32 s7, s7, 1024
    buffer_load_dwordx4 v17, s[40:43], s6 offen nt lds
    s_add_u32 s6, s6, 8192
    s_waitcnt vmcnt(11)
    s_mov_b32 m0, s7
    s_add_u32 s7, s7, 1024
    buffer_load_dwordx4 v16, s[40:43], s6 offen nt lds
    s_add_u32 s6, s6, 8192
    s_waitcnt vmcnt(11)
    s_mov_b32 m0, s7
    s_add_u32 s7, s7, 1024
    buffer_load_dwordx4 v16, s[40:43], s6 offen nt lds
    s_add_u32 s6, s6, 8192
    s_waitcnt vmcnt(11)
    s_mov_b32 m0, s7
    s_add_u32 s7, s7, 1024
    buffer_load_dwordx4 v17, s[40:43], s6 offen nt lds
    s_add_u32 s6, s6, 8192
    s_waitcnt vmcnt(11)
    s_mov_b32 m0, s7
    s_add_u32 s7, s7, 1024
    buffer_load_dwordx4 v17, s[40:43], s6 offen nt lds
    s_add_u32 s6, s6, 8192
    s_waitcnt vmcnt(11)
    s_mov_b32 m0, s7
    s_add_u32 s7, s7, 1024
    buffer_load_dwordx4 v16, s[40:43], s6 offen nt lds
    s_add_u32 s6, s6, 8192
    s_waitcnt vmcnt(11)
    s_mov_b32 m0, s7
    s_add_u32 s7, s7, 1024
    buffer_load_dwordx4 v16, s[40:43], s6 offen nt lds
    s_add_u32 s6, s6, 8192
    s_waitcnt vmcnt(11)
    s_mov_b32 m0, s7
    s_add_u32 s7, s7, 1024
    buffer_load_dwordx4 v17, s[40:43], s6 offen nt lds
    s_add_u32 s6, s6, 8192
    s_waitcnt vmcnt(11)
    s_mov_b32 m0, s7
    s_add_u32 s7, s7, 1024
    buffer_load_dwordx4 v17, s[40:43], s6 offen nt lds
    s_add_u32 s6, s6, 8192
L_a_bar2:
    v_and_b32 v56, 7, v0
    v_lshlrev_b32 v56, 2, v56
    v_lshl_add_u32 v56, v5, 1, v56
    v_bfe_u32 v57, v0, 4, 1
    v_add_u32 v56, v56, v57
    v_lshlrev_b32 v62, 1, v56
    s_lshr_b32 s6, s5, 2
    s_lshl_b32 s6, s6, 11
    s_lshl_b32 s7, s4, 8
    s_add_u32 s6, s6, s7
    s_and_b32 s7, s5, 3
    s_lshl_b32 s7, s7, 6
    s_add_u32 s6, s6, s7
    v_add_u32 v62, s6, v62
    buffer_load_ushort v63, v62, s[12:15], 0 offen
    v_mov_b32 v88, 0
    v_mov_b32 v89, 0
    v_mov_b32 v90, 0
    v_mov_b32 v91, 0
    v_mov_b32 v92, 0
    v_mov_b32 v93, 0
    v_mov_b32 v94, 0
    v_mov_b32 v95, 0
    s_waitcnt vmcnt(0)
    s_mov_b64 s[6:7], exec
    s_mov_b64 exec, 1
    ds_add_u32 v3, v4 offset:0
    s_mov_b64 exec, s[6:7]
Lw_12:
    ds_read_b32 v56, v3 offset:0
    s_waitcnt lgkmcnt(0)
    v_readfirstlane_b32 s6, v56
    s_nop 0
    s_cmp_ge_u32 s6, 8
    s_cbranch_scc1 Lwd_13
    s_sleep 4
    s_branch Lw_12
Lwd_13:
    s_cmp_ge_u32 s52, 28
    s_cbranch_scc1 L_a_ffn_done
    s_lshl_b32 s6, s3, 9
    v_add_u32 v22, s6, v58
    s_lshl_b32 s6, s3, 14
    s_add_u32 s6, s6, 32768
    v_add_u32 v23, s6, v18
    ds_read_b128 v[64:67], v22 offset:0
    ds_read_b128 v[68:71], v22 offset:64
    ds_read_b128 v[72:75], v22 offset:128
    ds_read_b128 v[76:79], v22 offset:192
    ds_read_b64_tr_b16 v[96:97], v23 offset:0
    ds_read_b64_tr_b16 v[98:99], v23 offset:256
    ds_read_b64_tr_b16 v[112:113], v23 offset:32
    ds_read_b64_tr_b16 v[114:115], v23 offset:288
    ds_read_b64_tr_b16 v[100:101], v23 offset:2048
    ds_read_b64_tr_b16 v[102:103], v23 offset:2304
    ds_read_b64_tr_b16 v[116:117], v23 offset:2080
    ds_read_b64_tr_b16 v[118:119], v23 offset:2336
    ds_read_b64_tr_b16 v[104:105], v23 offset:4096
    ds_read_b64_tr_b16 v[106:107], v23 offset:4352
    ds_read_b64_tr_b16 v[120:121], v23 offset:4128
    ds_read_b64_tr_b16 v[122:123], v23 offset:4384
    ds_read_b64_tr_b16 v[108:109], v23 offset:6144
    ds_read_b64_tr_b16 v[110:111], v23 offset:6400
    ds_read_b64_tr_b16 v[124:125], v23 offset:6176
    ds_read_b64_tr_b16 v[126:127], v23 offset:6432
    s_waitcnt lgkmcnt(0)
    v_mfma_f32_16x16x32_bf16 v[80:83], v[96:99], v[64:67], 0
    v_mfma_f32_16x16x32_bf16 v[84:87], v[112:115], v[64:67], 0
    v_mfma_f32_16x16x32_bf16 v[80:83], v[100:103], v[68:71], v[80:83]
    v_mfma_f32_16x16x32_bf16 v[84:87], v[116:119], v[68:71], v[84:87]
    v_mfma_f32_16x16x32_bf16 v[80:83], v[104:107], v[72:75], v[80:83]
    v_mfma_f32_16x16x32_bf16 v[84:87], v[120:123], v[72:75], v[84:87]
    v_mfma_f32_16x16x32_bf16 v[80:83], v[108:111], v[76:79], v[80:83]
    v_mfma_f32_16x16x32_bf16 v[84:87], v[124:127], v[76:79], v[84:87]
    s_nop 7
    ds_read_b128 v[64:67], v22 offset:256
    ds_read_b128 v[68:71], v22 offset:320
    ds_read_b128 v[72:75], v22 offset:384
    ds_read_b128 v[76:79], v22 offset:448
    ds_read_b64_tr_b16 v[96:97], v23 offset:8192
    ds_read_b64_tr_b16 v[98:99], v23 offset:8448
    ds_read_b64_tr_b16 v[112:113], v23 offset:8224
    ds_read_b64_tr_b16 v[114:115], v23 offset:8480
    ds_read_b64_tr_b16 v[100:101], v23 offset:10240
    ds_read_b64_tr_b16 v[102:103], v23 offset:10496
    ds_read_b64_tr_b16 v[116:117], v23 offset:10272
    ds_read_b64_tr_b16 v[118:119], v23 offset:10528
    ds_read_b64_tr_b16 v[104:105], v23 offset:12288
    ds_read_b64_tr_b16 v[106:107], v23 offset:12544
    ds_read_b64_tr_b16 v[120:121], v23 offset:12320
    ds_read_b64_tr_b16 v[122:123], v23 offset:12576
    ds_read_b64_tr_b16 v[108:109], v23 offset:14336
    ds_read_b64_tr_b16 v[110:111], v23 offset:14592
    ds_read_b64_tr_b16 v[124:125], v23 offset:14368
    ds_read_b64_tr_b16 v[126:127], v23 offset:14624
    s_waitcnt lgkmcnt(0)
    v_mfma_f32_16x16x32_bf16 v[80:83], v[96:99], v[64:67], v[80:83]
    v_mfma_f32_16x16x32_bf16 v[84:87], v[112:115], v[64:67], v[84:87]
    v_mfma_f32_16x16x32_bf16 v[80:83], v[100:103], v[68:71], v[80:83]
    v_mfma_f32_16x16x32_bf16 v[84:87], v[116:119], v[68:71], v[84:87]
    v_mfma_f32_16x16x32_bf16 v[80:83], v[104:107], v[72:75], v[80:83]
    v_mfma_f32_16x16x32_bf16 v[84:87], v[120:123], v[72:75], v[84:87]
    v_mfma_f32_16x16x32_bf16 v[80:83], v[108:111], v[76:79], v[80:83]
    v_mfma_f32_16x16x32_bf16 v[84:87], v[124:127], v[76:79], v[84:87]
    s_nop 7
    v_add_u32 v22, 98304, v20
    v_add_u32 v23, 98304, v21
    ds_read_b64_tr_b16 v[96:97], v22 offset:0
    ds_read_b64_tr_b16 v[98:99], v22 offset:1024
    ds_read_b64_tr_b16 v[100:101], v22 offset:8192
    ds_read_b64_tr_b16 v[102:103], v22 offset:9216
    ds_read_b64_tr_b16 v[104:105], v22 offset:16384
    ds_read_b64_tr_b16 v[106:107], v22 offset:17408
    ds_read_b64_tr_b16 v[108:109], v22 offset:24576
    ds_read_b64_tr_b16 v[110:111], v22 offset:25600
    ds_read_b64_tr_b16 v[112:113], v23 offset:0
    ds_read_b64_tr_b16 v[114:115], v23 offset:1024
    ds_read_b64_tr_b16 v[116:117], v23 offset:8192
    ds_read_b64_tr_b16 v[118:119], v23 offset:9216
    ds_read_b64_tr_b16 v[120:121], v23 offset:16384
    ds_read_b64_tr_b16 v[122:123], v23 offset:17408
    ds_read_b64_tr_b16 v[124:125], v23 offset:24576
    ds_read_b64_tr_b16 v[126:127], v23 offset:25600
    s_nop 7
    v_cndmask_b32 v28, v80, v84, s[44:45]
    v_cndmask_b32 v29, v81, v85, s[44:45]
    v_cndmask_b32 v30, v82, v86, s[44:45]
    v_cndmask_b32 v31, v83, v87, s[44:45]
    s_cmp_eq_u32 s3, 0
    s_cbranch_scc1 Lr_14
    ds_write_b128 v59, v[28:31]
    s_waitcnt vmcnt(0) lgkmcnt(0)
    s_mov_b64 s[6:7], exec
    s_mov_b64 exec, 1
    ds_add_u32 v3, v4 offset:28
    s_mov_b64 exec, s[6:7]
    s_branch L_a_hh
Lr_14:
Lw_15:
    ds_read_b32 v56, v3 offset:28
    s_waitcnt lgkmcnt(0)
    v_readfirstlane_b32 s6, v56
    s_nop 0
    s_cmp_ge_u32 s6, 6
    s_cbranch_scc1 Lwd_16
    s_sleep 0
    s_branch Lw_15
Lwd_16:
    ds_read_b128 v[132:135], v59 offset:1024
    ds_read_b128 v[136:139], v59 offset:2048
    ds_read_b128 v[140:143], v59 offset:3072
    s_waitcnt lgkmcnt(1)
    v_add_f32 v28, v28, v132
    v_add_f32 v29, v29, v133
    v_add_f32 v30, v30, v134
    v_add_f32 v31, v31, v135
    s_waitcnt lgkmcnt(0)
    v_add_f32 v136, v136, v140
    v_add_f32 v137, v137, v141
    v_add_f32 v138, v138, v142
    v_add_f32 v139, v139, v143
    v_add_f32 v28, v28, v136
    v_add_f32 v29, v29, v137
    v_add_f32 v30, v30, v138
    v_add_f32 v31, v31, v139
    v_cvt_pk_bf16_f32 v28, v28, v29
    v_cvt_pk_bf16_f32 v29, v30, v31
    v_cmp_eq_u32 vcc, -1, v28
    v_mov_b32 v30, 0x7fc07fc0
    s_nop 0
    v_cndmask_b32 v28, v28, v30, vcc
    v_cmp_eq_u32 vcc, -1, v29
    v_mov_b32 v30, 0x7fc07fc0
    s_nop 0
    v_cndmask_b32 v29, v29, v30, vcc
    v_lshrrev_b32 v56, 1, v10
    buffer_store_dwordx2 v[28:29], v56, s[8:11], s47 offen sc1
Lw_17:
    ds_read_b32 v56, v3 offset:8
    s_waitcnt lgkmcnt(0)
    v_readfirstlane_b32 s6, v56
    s_nop 0
    s_cmp_ge_u32 s6, 6
    s_cbranch_scc1 Lwd_18
    s_sleep 16
    s_branch Lw_17
Lwd_18:
    s_lshl_b32 s60, s5, 12
    s_add_u32 s60, s60, 0x340000
    s_mov_b32 s53, 20000
    buffer_load_dwordx4 v[128:131], v7, s[8:11], s60 offen offset:0 sc1
    buffer_load_dwordx4 v[132:135], v7, s[8:11], s60 offen offset:1024 sc1
    buffer_load_dwordx4 v[136:139], v7, s[8:11], s60 offen offset:2048 sc1
    buffer_load_dwordx4 v[140:143], v7, s[8:11], s60 offen offset:3072 sc1
Lp_19:
    s_waitcnt vmcnt(0)
    v_max3_u32 v57, v128, v129, v130
    v_max_u32 v57, v57, v131
    v_cmp_eq_u32 s[72:73], -1, v57
    v_max3_u32 v57, v132, v133, v134
    v_max_u32 v57, v57, v135
    v_cmp_eq_u32 s[74:75], -1, v57
    v_max3_u32 v57, v136, v137, v138
    v_max_u32 v57, v57, v139
    v_cmp_eq_u32 s[76:77], -1, v57
    v_max3_u32 v57, v140, v141, v142
    v_max_u32 v57, v57, v143
    v_cmp_eq_u32 s[78:79], -1, v57
    s_or_b64 vcc, s[72:73], s[74:75]
    s_or_b64 vcc, vcc, s[76:77]
    s_or_b64 vcc, vcc, s[78:79]
    s_cbranch_scc0 Lpd_20
    s_sub_u32 s53, s53, 1
    s_cbranch_scc1 Lpd_20
    s_sleep 32
    s_wqm_b64 exec, s[72:73]
    s_cbranch_execz Lps_21
    buffer_load_dwordx4 v[128:131], v7, s[8:11], s60 offen offset:0 sc1
Lps_21:
    s_wqm_b64 exec, s[74:75]
    s_cbranch_execz Lps_22
    buffer_load_dwordx4 v[132:135], v7, s[8:11], s60 offen offset:1024 sc1
Lps_22:
    s_wqm_b64 exec, s[76:77]
    s_cbranch_execz Lps_23
    buffer_load_dwordx4 v[136:139], v7, s[8:11], s60 offen offset:2048 sc1
Lps_23:
    s_wqm_b64 exec, s[78:79]
    s_cbranch_execz Lps_24
    buffer_load_dwordx4 v[140:143], v7, s[8:11], s60 offen offset:3072 sc1
Lps_24:
    s_mov_b64 exec, -1
    s_branch Lp_19
Lpd_20:
    v_lshlrev_b32 v144, 16, v128
    v_and_b32 v145, 0xffff0000, v128
    v_lshlrev_b32 v146, 16, v136
    v_and_b32 v147, 0xffff0000, v136
    v_mul_f32 v144, v144, v146
    v_mul_f32 v145, v145, v147
    v_cvt_pk_bf16_f32 v128, v144, v145
    v_lshlrev_b32 v144, 16, v129
    v_and_b32 v145, 0xffff0000, v129
    v_lshlrev_b32 v146, 16, v137
    v_and_b32 v147, 0xffff0000, v137
    v_mul_f32 v144, v144, v146
    v_mul_f32 v145, v145, v147
    v_cvt_pk_bf16_f32 v129, v144, v145
    v_lshlrev_b32 v144, 16, v130
    v_and_b32 v145, 0xffff0000, v130
    v_lshlrev_b32 v146, 16, v138
    v_and_b32 v147, 0xffff0000, v138
    v_mul_f32 v144, v144, v146
    v_mul_f32 v145, v145, v147
    v_cvt_pk_bf16_f32 v130, v144, v145
    v_lshlrev_b32 v144, 16, v131
    v_and_b32 v145, 0xffff0000, v131
    v_lshlrev_b32 v146, 16, v139
    v_and_b32 v147, 0xffff0000, v139
    v_mul_f32 v144, v144, v146
    v_mul_f32 v145, v145, v147
    v_cvt_pk_bf16_f32 v131, v144, v145
    v_lshlrev_b32 v144, 16, v132
    v_and_b32 v145, 0xffff0000, v132
    v_lshlrev_b32 v146, 16, v140
    v_and_b32 v147, 0xffff0000, v140
    v_mul_f32 v144, v144, v146
    v_mul_f32 v145, v145, v147
    v_cvt_pk_bf16_f32 v132, v144, v145
    v_lshlrev_b32 v144, 16, v133
    v_and_b32 v145, 0xffff0000, v133
    v_lshlrev_b32 v146, 16, v141
    v_and_b32 v147, 0xffff0000, v141
    v_mul_f32 v144, v144, v146
    v_mul_f32 v145, v145, v147
    v_cvt_pk_bf16_f32 v133, v144, v145
    v_lshlrev_b32 v144, 16, v134
    v_and_b32 v145, 0xffff0000, v134
    v_lshlrev_b32 v146, 16, v142
    v_and_b32 v147, 0xffff0000, v142
    v_mul_f32 v144, v144, v146
    v_mul_f32 v145, v145, v147
    v_cvt_pk_bf16_f32 v134, v144, v145
    v_lshlrev_b32 v144, 16, v135
    v_and_b32 v145, 0xffff0000, v135
    v_lshlrev_b32 v146, 16, v143
    v_and_b32 v147, 0xffff0000, v143
    v_mul_f32 v144, v144, v146
    v_mul_f32 v145, v145, v147
    v_cvt_pk_bf16_f32 v135, v144, v145
    v_bfe_u32 v56, v0, 2, 3
    v_mul_u32_u24 v56, 272, v56
    v_lshl_add_u32 v56, v5, 6, v56
    v_and_b32 v57, 3, v0
    v_lshl_add_u32 v56, v57, 4, v56
    v_add_u32 v56, 147584, v56
    ds_write_b128 v56, v[128:131]
    ds_write_b128 v56, v[132:135] offset:128
    s_waitcnt lgkmcnt(0)
    s_mov_b64 s[6:7], exec
    s_mov_b64 exec, 1
    ds_add_u32 v3, v4 offset:32
    s_mov_b64 exec, s[6:7]
L_a_hh:
Lw_25:
    ds_read_b32 v56, v3 offset:32
    s_waitcnt lgkmcnt(0)
    v_readfirstlane_b32 s6, v56
    s_nop 0
    s_cmp_ge_u32 s6, 1
    s_cbranch_scc1 Lwd_26
    s_sleep 16
    s_branch Lw_25
Lwd_26:
    ds_read_b128 v[32:35], v26 offset:0
    ds_read_b128 v[36:39], v26 offset:64
    ds_read_b128 v[40:43], v26 offset:128
    ds_read_b128 v[44:47], v26 offset:192
    s_waitcnt lgkmcnt(0)
    v_mfma_f32_16x16x32_bf16 v[88:91], v[96:99], v[32:35], v[88:91]
    v_mfma_f32_16x16x32_bf16 v[92:95], v[112:115], v[32:35], v[92:95]
    v_mfma_f32_16x16x32_bf16 v[88:91], v[100:103], v[36:39], v[88:91]
    v_mfma_f32_16x16x32_bf16 v[92:95], v[116:119], v[36:39], v[92:95]
    v_mfma_f32_16x16x32_bf16 v[88:91], v[104:107], v[40:43], v[88:91]
    v_mfma_f32_16x16x32_bf16 v[92:95], v[120:123], v[40:43], v[92:95]
    v_mfma_f32_16x16x32_bf16 v[88:91], v[108:111], v[44:47], v[88:91]
    v_mfma_f32_16x16x32_bf16 v[92:95], v[124:127], v[44:47], v[92:95]
    s_nop 7
L_a_ffn_done:
    v_lshrrev_b32 v56, 3, v0
    s_and_b32 s6, s5, 7
    v_xor_b32 v56, s6, v56
    v_lshlrev_b32 v56, 12, v56
    v_and_b32 v57, 7, v0
    v_lshl_add_u32 v58, v57, 4, v56
    s_lshl_b32 s7, s4, 17
    s_lshl_b32 s6, s5, 7
    s_add_u32 s7, s7, s6
    s_add_u32 s7, s7, 0x400000
    s_lshr_b32 s6, s5, 3
    s_xor_b32 s16, s6, 0
    s_lshl_b32 s16, s16, 15
    s_add_u32 s16, s16, s7
    s_xor_b32 s17, s6, 1
    s_lshl_b32 s17, s17, 15
    s_add_u32 s17, s17, s7
    s_xor_b32 s18, s6, 2
    s_lshl_b32 s18, s18, 15
    s_add_u32 s18, s18, s7
    s_xor_b32 s19, s6, 3
    s_lshl_b32 s19, s19, 15
    s_add_u32 s19, s19, s7
    v_mov_b32 v55, 0x200000
    v_cmp_gt_u32 vcc, 8, v0
    v_cndmask_b32 v55, 0, v55, vcc
    v_xor_b32 v58, v58, v55
    s_add_u32 s65, s48, 0x200000
    s_and_b32 s66, s5, 3
    s_bitcmp1_b32 s5, 2
    s_mov_b32 s67, 0x55555555
    s_cselect_b32 s67, 0xaaaaaaaa, s67
    v_add_u32 v22, 0, v20
    v_add_u32 v23, 0, v21
    ds_read_b64_tr_b16 v[96:97], v22 offset:0
    ds_read_b64_tr_b16 v[98:99], v22 offset:1024
    ds_read_b64_tr_b16 v[100:101], v22 offset:8192
    ds_read_b64_tr_b16 v[102:103], v22 offset:9216
    ds_read_b64_tr_b16 v[104:105], v22 offset:16384
    ds_read_b64_tr_b16 v[106:107], v22 offset:17408
    ds_read_b64_tr_b16 v[108:109], v22 offset:24576
    ds_read_b64_tr_b16 v[110:111], v22 offset:25600
    ds_read_b64_tr_b16 v[112:113], v23 offset:0
    ds_read_b64_tr_b16 v[114:115], v23 offset:1024
    ds_read_b64_tr_b16 v[116:117], v23 offset:8192
    ds_read_b64_tr_b16 v[118:119], v23 offset:9216
    ds_read_b64_tr_b16 v[120:121], v23 offset:16384
    ds_read_b64_tr_b16 v[122:123], v23 offset:17408
    ds_read_b64_tr_b16 v[124:125], v23 offset:24576
    ds_read_b64_tr_b16 v[126:127], v23 offset:25600
    s_lshl_b32 s60, s5, 11
    s_add_u32 s60, s60, 0x320000
Lw_27:
    ds_read_b32 v56, v3 offset:8
    s_waitcnt lgkmcnt(0)
    v_readfirstlane_b32 s6, v56
    s_nop 0
    s_cmp_ge_u32 s6, 30
    s_cbranch_scc1 Lwd_28
    s_sleep 16
    s_branch Lw_27
Lwd_28:
    s_cmp_lg_u32 s3, 0
    s_cbranch_scc1 L_a_late123
    v_lshlrev_b32 v56, 3, v0
    v_add_u32 v56, 150016, v56
    v_mov_b32 v57, 154112
Lw_29:
    ds_read_b32 v61, v3 offset:16
    s_waitcnt lgkmcnt(0)
    v_readfirstlane_b32 s6, v61
    s_nop 0
    s_cmp_ge_u32 s6, 4
    s_cbranch_scc1 Lwd_30
    s_sleep 0
    s_branch Lw_29
Lwd_30:
    ds_read_b128 v[128:131], v57
    ds_read_b128 v[132:135], v57 offset:16
    ds_read_b64 v[136:137], v56 offset:0
    ds_read_b64 v[138:139], v56 offset:512
    ds_read_b64 v[140:141], v56 offset:1024
    ds_read_b64 v[142:143], v56 offset:1536
    s_waitcnt lgkmcnt(4)
    v_max3_f32 v144, v128, v130, v132
    v_max_f32 v144, v144, v134
    v_sub_f32 v128, v128, v144
    v_sub_f32 v130, v130, v144
    v_sub_f32 v132, v132, v144
    v_sub_f32 v134, v134, v144
    v_exp_f32 v128, v128
    v_exp_f32 v130, v130
    v_exp_f32 v132, v132
    v_exp_f32 v134, v134
    s_nop 0
    v_mul_f32 v145, v128, v129
    v_fmac_f32 v145, v130, v131
    v_fmac_f32 v145, v132, v133
    v_fmac_f32 v145, v134, v135
    v_rcp_f32 v145, v145
    s_waitcnt lgkmcnt(0)
    v_mul_f32 v146, v128, v136
    v_mul_f32 v147, v128, v137
    v_fmac_f32 v146, v130, v138
    v_fmac_f32 v147, v130, v139
    v_fmac_f32 v146, v132, v140
    v_fmac_f32 v147, v132, v141
    v_fmac_f32 v146, v134, v142
    v_fmac_f32 v147, v134, v143
    v_mul_f32 v146, v146, v145
    v_mul_f32 v147, v147, v145
    v_cvt_pk_bf16_f32 v48, v146, v147
    v_cmp_eq_u32 vcc, -1, v48
    v_mov_b32 v147, 0x7fc07fc0
    s_nop 0
    v_cndmask_b32 v48, v48, v147, vcc
    buffer_store_dword v48, v25, s[8:11], s58 offen
    s_branch L_a_zo
L_a_late123:
Lw_31:
    ds_read_b32 v56, v3 offset:16
    s_waitcnt lgkmcnt(0)
    v_readfirstlane_b32 s6, v56
    s_nop 0
    s_cmp_ge_u32 s6, 4
    s_cbranch_scc1 Lwd_32
    s_sleep 1
    s_branch Lw_31
Lwd_32:
    s_sleep 8
L_a_zo:
    s_mov_b32 s53, 20000
    buffer_load_dwordx4 v[64:67], v27, s[8:11], s60 offen offset:0 sc1
    buffer_load_dwordx4 v[68:71], v27, s[8:11], s60 offen offset:128 sc1
Lp_33:
    s_waitcnt vmcnt(0)
    v_max3_u32 v57, v64, v65, v66
    v_max_u32 v57, v57, v67
    v_cmp_eq_u32 s[72:73], -1, v57
    v_max3_u32 v57, v68, v69, v70
    v_max_u32 v57, v57, v71
    v_cmp_eq_u32 s[74:75], -1, v57
    s_or_b64 vcc, s[72:73], s[74:75]
    s_cbranch_scc0 Lpd_34
    s_sub_u32 s53, s53, 1
    s_cbranch_scc1 Lpd_34
    s_cmp_gt_u32 s53, 19984
    s_cbranch_scc1 Lpa_35
    s_xor_b32 s60, s60, 0x20000
    s_cmp_lg_u32 s53, 19984
    s_cbranch_scc1 Lpa_35
    s_cmp_lg_u32 s3, 0
    s_cbranch_scc1 Lz_36
    buffer_store_dword v48, v25, s[8:11], s51 offen sc1
Lz_36:
Lpa_35:
    s_wqm_b64 exec, s[72:73]
    s_cbranch_execz Lps_37
    buffer_load_dwordx4 v[64:67], v27, s[8:11], s60 offen offset:0 sc1
Lps_37:
    s_wqm_b64 exec, s[74:75]
    s_cbranch_execz Lps_38
    buffer_load_dwordx4 v[68:71], v27, s[8:11], s60 offen offset:128 sc1
Lps_38:
    s_mov_b64 exec, -1
    s_branch Lp_33
Lpd_34:
    s_cmp_lg_u32 s3, 0
    s_cbranch_scc1 Lz_39
    buffer_store_dword v48, v25, s[8:11], s51 offen sc1
Lz_39:
    s_waitcnt lgkmcnt(0)
    v_mfma_f32_16x16x32_bf16 v[80:83], v[112:115], v[64:67], 0
    v_mfma_f32_16x16x32_bf16 v[84:87], v[100:103], v[64:67], 0
    v_mfma_f32_16x16x32_bf16 v[88:91], v[96:99], v[64:67], v[88:91]
    v_mfma_f32_16x16x32_bf16 v[92:95], v[116:119], v[64:67], v[92:95]
    v_mfma_f32_16x16x32_bf16 v[80:83], v[120:123], v[68:71], v[80:83]
    v_mfma_f32_16x16x32_bf16 v[84:87], v[108:111], v[68:71], v[84:87]
    v_mfma_f32_16x16x32_bf16 v[88:91], v[104:107], v[68:71], v[88:91]
    v_mfma_f32_16x16x32_bf16 v[92:95], v[124:127], v[68:71], v[92:95]
    s_nop 7
    v_cndmask_b32 v72, v80, v84, s[44:45]
    v_cndmask_b32 v73, v81, v85, s[44:45]
    v_cndmask_b32 v74, v82, v86, s[44:45]
    v_cndmask_b32 v75, v83, v87, s[44:45]
    v_cndmask_b32 v28, v88, v92, s[44:45]
    v_cndmask_b32 v29, v89, v93, s[44:45]
    v_cndmask_b32 v30, v90, v94, s[44:45]
    v_cndmask_b32 v31, v91, v95, s[44:45]
    v_add_f32_dpp v28, v72, v28 row_ror:8 row_mask:0xf bank_mask:0xf
    v_add_f32_dpp v29, v73, v29 row_ror:8 row_mask:0xf bank_mask:0xf
    v_add_f32_dpp v30, v74, v30 row_ror:8 row_mask:0xf bank_mask:0xf
    v_add_f32_dpp v31, v75, v31 row_ror:8 row_mask:0xf bank_mask:0xf
    v_add_u32 v28, 0x80, v28
    v_add_u32 v29, 0x80, v29
    v_add_u32 v30, 0x80, v30
    v_add_u32 v31, 0x80, v31
    v_and_or_b32 v28, v28, s80, v12
    v_and_or_b32 v29, v29, s80, v13
    v_and_or_b32 v30, v30, s80, v14
    v_and_or_b32 v31, v31, s80, v15
    s_cmp_lg_u32 s3, s66
    s_cbranch_scc1 L_a_noo2
    s_mov_b32 exec_lo, s67
    s_mov_b32 exec_hi, s67
    buffer_store_dwordx4 v[28:31], v24, s[8:11], s65 offen
    s_mov_b64 exec, -1
L_a_noo2:
    buffer_store_dwordx4 v[28:31], v24, s[8:11], s48 offen sc1
    s_cmp_lg_u32 s3, 0
    s_cbranch_scc1 L_done
    s_sleep 10
    s_mov_b32 s53, 20000
    buffer_load_dwordx4 v[128:131], v58, s[8:11], s16 offen sc1
    buffer_load_dwordx4 v[132:135], v58, s[8:11], s17 offen sc1
    buffer_load_dwordx4 v[136:139], v58, s[8:11], s18 offen sc1
    buffer_load_dwordx4 v[140:143], v58, s[8:11], s19 offen sc1
Lp_40:
    s_waitcnt vmcnt(0)
    v_perm_b32 v57, v129, v128, s81
    v_perm_b32 v56, v131, v130, s82
    v_or_b32 v57, v57, v56
    v_cmp_ne_u32 s[72:73], v57, v19
    v_perm_b32 v57, v133, v132, s81
    v_perm_b32 v56, v135, v134, s82
    v_or_b32 v57, v57, v56
    v_cmp_ne_u32 s[74:75], v57, v19
    v_perm_b32 v57, v137, v136, s81
    v_perm_b32 v56, v139, v138, s82
    v_or_b32 v57, v57, v56
    v_cmp_ne_u32 s[76:77], v57, v19
    v_perm_b32 v57, v141, v140, s81
    v_perm_b32 v56, v143, v142, s82
    v_or_b32 v57, v57, v56
    v_cmp_ne_u32 s[78:79], v57, v19
    s_or_b64 vcc, s[72:73], s[74:75]
    s_or_b64 vcc, vcc, s[76:77]
    s_or_b64 vcc, vcc, s[78:79]
    s_cbranch_scc0 Lpd_41
    s_sub_u32 s53, s53, 1
    s_cbranch_scc1 Lpd_41
    s_cmp_gt_u32 s53, 19990
    s_cbranch_scc1 Lpa_42
    v_xor_b32 v58, v58, v55
Lpa_42:
    s_wqm_b64 exec, s[72:73]
    s_cbranch_execz Lps_43
    buffer_load_dwordx4 v[128:131], v58, s[8:11], s16 offen sc1
Lps_43:
    s_wqm_b64 exec, s[74:75]
    s_cbranch_execz Lps_44
    buffer_load_dwordx4 v[132:135], v58, s[8:11], s17 offen sc1
Lps_44:
    s_wqm_b64 exec, s[76:77]
    s_cbranch_execz Lps_45
    buffer_load_dwordx4 v[136:139], v58, s[8:11], s18 offen sc1
Lps_45:
    s_wqm_b64 exec, s[78:79]
    s_cbranch_execz Lps_46
    buffer_load_dwordx4 v[140:143], v58, s[8:11], s19 offen sc1
Lps_46:
    s_mov_b64 exec, -1
    s_branch Lp_40
Lpd_41:
    v_and_b32 v96, s80, v128
    v_and_b32 v97, s80, v129
    v_and_b32 v98, s80, v130
    v_and_b32 v99, s80, v131
    v_and_b32 v100, s80, v132
    v_and_b32 v101, s80, v133
    v_and_b32 v102, s80, v134
    v_and_b32 v103, s80, v135
    v_and_b32 v104, s80, v136
    v_and_b32 v105, s80, v137
    v_and_b32 v106, s80, v138
    v_and_b32 v107, s80, v139
    v_and_b32 v108, s80, v140
    v_and_b32 v109, s80, v141
    v_and_b32 v110, s80, v142
    v_and_b32 v111, s80, v143
    v_add_f32 v96, v96, v100
    v_add_f32 v104, v104, v108
    v_add_f32 v97, v97, v101
    v_add_f32 v105, v105, v109
    v_add_f32 v98, v98, v102
    v_add_f32 v106, v106, v110
    v_add_f32 v99, v99, v103
    v_add_f32 v107, v107, v111
    v_add_f32 v96, v96, v104
    v_add_f32 v97, v97, v105
    v_add_f32 v98, v98, v106
    v_add_f32 v99, v99, v107
    s_nop 1
    v_permlane32_swap_b32 v96, v98
    v_permlane32_swap_b32 v97, v99
    s_nop 1
    v_add_f32 v144, v96, v98
    v_add_f32 v145, v97, v99
    s_nop 1
    v_permlane16_swap_b32 v144, v145
    s_nop 1
    v_add_f32 v144, v144, v145
    v_lshlrev_b32 v63, 16, v63
    s_nop 0
    v_add_f32_dpp v144, v144, v144 row_ror:8 row_mask:0xf bank_mask:0xf
    v_add_f32 v144, v144, v63
    v_cvt_pk_bf16_f32 v144, v144, v144
    s_mov_b32 s40, s34
    s_mov_b32 s41, s35
    s_mov_b32 s42, 0x4000
    s_mov_b32 s43, 0x20000
    s_mov_b32 exec_lo, 0x00ff00ff
    s_mov_b32 exec_hi, 0x00ff00ff
    buffer_store_short v144, v62, s[40:43], 0 offen
    s_cmp_lg_u32 s2, 0
    s_cbranch_scc1 L_a_noep
    s_mov_b64 exec, 1
    v_mov_b32 v56, s83
    v_mov_b32 v57, 0x700000
    buffer_store_dword v56, v57, s[8:11], 0 offen
L_a_noep:
    s_mov_b64 exec, -1
    s_branch L_done
L_flow:
    s_setprio 2
    s_mov_b32 s53, 0x700000
    v_lshlrev_b32 v25, 2, v0
    s_waitcnt lgkmcnt(0)
    s_load_dword s83, s[38:39], s53
    s_mov_b32 s8, s38
    s_mov_b32 s9, s39
    s_mov_b32 s10, 0x800000
    s_mov_b32 s11, 0x20000
    s_barrier
    s_mov_b32 s60, 0x2a222222
    s_waitcnt lgkmcnt(0)
    s_add_u32 s83, s83, 0x9e3779b9
    s_bitset0_b32 s83, 0
    v_mov_b32 v57, s83
    s_cmp_eq_u32 s3, 9
    s_cbranch_scc1 L_f_read
    s_lshl_b32 s61, s2, 12
    s_add_u32 s61, s61, 0x500000
    s_mov_b32 exec_hi, 0
L_f_pub:
    s_ff1_i32_b32 s63, s60
    s_bitset0_b32 s60, s63
    s_lshl_b32 s62, s63, 7
    s_add_u32 s62, s62, s61
Lw_47:
    ds_read_b32 v56, v3 offset:8
    s_waitcnt lgkmcnt(0)
    v_readfirstlane_b32 s6, v56
    s_nop 0
    s_cmp_ge_u32 s6, s63
    s_cbranch_scc1 Lwd_48
    s_sleep 2
    s_branch Lw_47
Lwd_48:
    buffer_store_dword v57, v25, s[8:11], s62 offen sc1
    s_cmp_lg_u32 s60, 0
    s_cbranch_scc1 L_f_pub
    s_endpgm
L_f_read:
    v_add_u32 v56, s2, v0
    v_add_u32 v56, 1, v56
    v_and_b32 v56, 7, v56
    v_lshlrev_b32 v61, 12, v56
    v_mad_u32_u24 v56, v0, v0, v0
    s_lshr_b32 s62, s2, 3
    s_add_u32 s62, s62, 1
    v_add_u32 v56, s62, v56
    v_and_b32 v56, 31, v56
    v_lshl_add_u32 v61, v56, 15, v61
    s_mov_b32 s54, 20000
L_f_rd:
    s_ff1_i32_b32 s63, s60
    s_bitset0_b32 s60, s63
    s_sub_u32 s6, 255, s63
    v_mov_b32 v58, s6
    ds_write_b32 v3, v58 offset:24
    s_lshl_b32 s62, s63, 7
    s_add_u32 s62, s62, 0x500000
    s_add_u32 s55, s63, 0
Lw_49:
    ds_read_b32 v56, v3 offset:8
    s_waitcnt lgkmcnt(0)
    v_readfirstlane_b32 s6, v56
    s_nop 0
    s_cmp_ge_u32 s6, s55
    s_cbranch_scc1 Lwd_50
    s_sleep 2
    s_branch Lw_49
Lwd_50:
    s_sleep 32
    s_mov_b64 exec, 0x7f
L_f_rt:
    buffer_load_dword v59, v61, s[8:11], s62 offen sc1
    s_waitcnt vmcnt(0)
    v_cmp_ne_u32 vcc, v59, v57
    s_sub_u32 s54, s54, 1
    s_cbranch_scc1 L_f_rdd
    s_and_b64 exec, exec, vcc
    s_cbranch_execz L_f_ok
    s_sleep 2
    s_branch L_f_rt
L_f_ok:
    s_mov_b64 exec, -1
    s_cmp_lg_u32 s60, 0
    s_cbranch_scc1 L_f_rd
L_f_rdd:
    s_mov_b64 exec, -1
    ds_write_b32 v3, v2 offset:24
    s_endpgm
L_stream:
    s_sub_u32 s3, s3, 4
    v_lshlrev_b32 v5, 4, v0
    s_lshl_b32 s6, s3, 10
    s_lshl_b32 s7, s2, 20
    s_add_u32 s6, s6, s7
    v_add_u32 v5, s6, v5
    s_mov_b32 s6, 0
    s_lshl_b32 s6, s3, 1
    s_lshl_b32 s6, s6, 12
    s_and_b32 s64, s6, 0xf000
    s_add_u32 s6, s6, 0x1000
    s_and_b32 s65, s6, 0xf000
    s_add_u32 s6, s6, 0x1000
    s_and_b32 s66, s6, 0xf000
    s_add_u32 s6, s6, 0x1000
    s_and_b32 s67, s6, 0xf000
    s_add_u32 s6, s6, 0x1000
    s_and_b32 s68, s6, 0xf000
    s_add_u32 s6, s6, 0x1000
    s_and_b32 s69, s6, 0xf000
    s_add_u32 s6, s6, 0x1000
    s_and_b32 s70, s6, 0xf000
    s_add_u32 s6, s6, 0x1000
    s_and_b32 s71, s6, 0xf000
    s_add_u32 s6, s6, 0x1000
    s_and_b32 s72, s6, 0xf000
    s_add_u32 s6, s6, 0x1000
    s_and_b32 s73, s6, 0xf000
    s_add_u32 s6, s6, 0x1000
    s_and_b32 s74, s6, 0xf000
    s_add_u32 s6, s6, 0x1000
    s_and_b32 s75, s6, 0xf000
    s_add_u32 s6, s6, 0x1000
    s_and_b32 s76, s6, 0xf000
    s_add_u32 s6, s6, 0x1000
    s_and_b32 s77, s6, 0xf000
    s_add_u32 s6, s6, 0x1000
    s_and_b32 s78, s6, 0xf000
    s_add_u32 s6, s6, 0x1000
    s_and_b32 s79, s6, 0xf000
    s_add_u32 s6, s6, 0x1000
    s_mov_b32 s52, 0
    v_add_u32 v6, s52, v5
    s_waitcnt lgkmcnt(0)
    s_mov_b32 s8, s18
    s_mov_b32 s9, s19
    s_mov_b32 s10, 0x10000000
    s_mov_b32 s11, 0x20000
    buffer_load_dwordx4 v[64:67], v6, s[8:11], s64 offen nt
    buffer_load_dwordx4 v[68:71], v6, s[8:11], s65 offen nt
    buffer_load_dwordx4 v[72:75], v6, s[8:11], s66 offen nt
    buffer_load_dwordx4 v[76:79], v6, s[8:11], s67 offen nt
    s_barrier
    v_and_b32 v10, 15, v0
    v_lshlrev_b32 v8, 4, v10
    v_add_u32 v8, 149760, v8
    v_lshlrev_b32 v9, 5, v10
    v_lshrrev_b32 v11, 4, v0
    v_lshl_add_u32 v9, v11, 3, v9
    s_lshl_b32 s6, s3, 9
    s_add_u32 s6, s6, 150016
    v_add_u32 v9, s6, v9
    v_and_b32 v10, 2, v0
    v_cmp_ne_u32 s[46:47], 0, v10
    v_and_b32 v10, 1, v0
    v_cmp_ne_u32 s[44:45], 0, v10
    s_mov_b32 s48, 0x3db504f3
    s_mov_b32 s49, 0x3fb8aa3b
    s_mov_b32 s53, 0
    v_mov_b32 v16, 0
    v_mov_b32 v17, 0
    v_mov_b32 v18, 0
    v_mov_b32 v19, 0
    v_mov_b32 v20, 0
    v_mov_b32 v21, 0
    v_mov_b32 v22, 0
    v_mov_b32 v23, 0
    buffer_load_dwordx4 v[80:83], v6, s[8:11], s68 offen nt
    buffer_load_dwordx4 v[84:87], v6, s[8:11], s69 offen nt
    buffer_load_dwordx4 v[88:91], v6, s[8:11], s70 offen nt
    buffer_load_dwordx4 v[92:95], v6, s[8:11], s71 offen nt
    s_waitcnt vmcnt(7)
    buffer_load_dwordx4 v[96:99], v6, s[8:11], s72 offen nt
    s_waitcnt vmcnt(7)
    buffer_load_dwordx4 v[100:103], v6, s[8:11], s73 offen nt
    s_waitcnt vmcnt(7)
    buffer_load_dwordx4 v[104:107], v6, s[8:11], s74 offen nt
    s_waitcnt vmcnt(7)
    buffer_load_dwordx4 v[108:111], v6, s[8:11], s75 offen nt
    s_waitcnt vmcnt(7)
    buffer_load_dwordx4 v[112:115], v6, s[8:11], s76 offen nt
    s_waitcnt vmcnt(7)
    buffer_load_dwordx4 v[116:119], v6, s[8:11], s77 offen nt
    s_waitcnt vmcnt(7)
    buffer_load_dwordx4 v[120:123], v6, s[8:11], s78 offen nt
    s_waitcnt vmcnt(7)
    buffer_load_dwordx4 v[124:127], v6, s[8:11], s79 offen nt
    s_mov_b64 exec, 1
    ds_add_u32 v3, v4 offset:12
    s_mov_b64 exec, -1
Lw_51:
    ds_read_b32 v10, v3 offset:4
    s_waitcnt lgkmcnt(0)
    v_readfirstlane_b32 s6, v10
    s_nop 0
    s_cmp_ge_u32 s6, 1
    s_cbranch_scc1 Lwd_52
    s_sleep 2
    s_branch Lw_51
Lwd_52:
    ds_read_b128 v[12:15], v8
    s_waitcnt lgkmcnt(0)
L_s_k:
    s_add_u32 s52, s52, 65536
    s_and_b32 s52, s52, 0xf0000
    s_cmp_ge_u32 s53, 15
    s_cselect_b32 s8, s20, s18
    s_cselect_b32 s9, s21, s19
    v_add_u32 v6, s52, v5
Lfc_53:
    ds_read_b32 v7, v3 offset:24
    s_waitcnt lgkmcnt(0)
    v_readfirstlane_b32 s7, v7
    s_nop 0
    s_add_u32 s7, s7, s53
    s_cmp_le_u32 s7, 255
    s_cbranch_scc1 Lfg_54
    s_sleep 4
    s_branch Lfc_53
Lfg_54:
    s_add_u32 s53, s53, 1
    v_mov_b32 v40, v41
    v_mov_b32 v41, v42
    v_mov_b32 v42, v43
    v_mov_b32 v43, v44
    v_mov_b32 v44, v45
    v_mov_b32 v45, v46
    v_mov_b32 v46, v47
    v_mov_b32 v47, v48
    v_mov_b32 v48, v49
    v_mov_b32 v49, v50
    v_mov_b32 v50, v51
    v_mov_b32 v51, v52
    v_mov_b32 v52, v53
    v_mov_b32 v53, v54
    v_mov_b32 v54, v55
    s_waitcnt vmcnt(15)
    v_dot2_f32_bf16 v24, v64, v12, 0
    v_dot2_f32_bf16 v24, v65, v13, v24
    v_dot2_f32_bf16 v24, v66, v14, v24
    v_dot2_f32_bf16 v24, v67, v15, v24
    buffer_load_dwordx4 v[64:67], v6, s[8:11], s64 offen nt
    s_waitcnt vmcnt(15)
    v_dot2_f32_bf16 v25, v68, v12, 0
    v_dot2_f32_bf16 v25, v69, v13, v25
    v_dot2_f32_bf16 v25, v70, v14, v25
    v_dot2_f32_bf16 v25, v71, v15, v25
    buffer_load_dwordx4 v[68:71], v6, s[8:11], s65 offen nt
    s_waitcnt vmcnt(15)
    v_dot2_f32_bf16 v26, v72, v12, 0
    v_dot2_f32_bf16 v26, v73, v13, v26
    v_dot2_f32_bf16 v26, v74, v14, v26
    v_dot2_f32_bf16 v26, v75, v15, v26
    buffer_load_dwordx4 v[72:75], v6, s[8:11], s66 offen nt
    s_waitcnt vmcnt(15)
    v_dot2_f32_bf16 v27, v76, v12, 0
    v_dot2_f32_bf16 v27, v77, v13, v27
    v_dot2_f32_bf16 v27, v78, v14, v27
    v_dot2_f32_bf16 v27, v79, v15, v27
    buffer_load_dwordx4 v[76:79], v6, s[8:11], s67 offen nt
    s_waitcnt vmcnt(15)
    v_dot2_f32_bf16 v28, v80, v12, 0
    v_dot2_f32_bf16 v28, v81, v13, v28
    v_dot2_f32_bf16 v28, v82, v14, v28
    v_dot2_f32_bf16 v28, v83, v15, v28
    buffer_load_dwordx4 v[80:83], v6, s[8:11], s68 offen nt
    s_waitcnt vmcnt(15)
    v_dot2_f32_bf16 v29, v84, v12, 0
    v_dot2_f32_bf16 v29, v85, v13, v29
    v_dot2_f32_bf16 v29, v86, v14, v29
    v_dot2_f32_bf16 v29, v87, v15, v29
    buffer_load_dwordx4 v[84:87], v6, s[8:11], s69 offen nt
    s_waitcnt vmcnt(15)
    v_dot2_f32_bf16 v30, v88, v12, 0
    v_dot2_f32_bf16 v30, v89, v13, v30
    v_dot2_f32_bf16 v30, v90, v14, v30
    v_dot2_f32_bf16 v30, v91, v15, v30
    buffer_load_dwordx4 v[88:91], v6, s[8:11], s70 offen nt
    s_waitcnt vmcnt(15)
    v_dot2_f32_bf16 v31, v92, v12, 0
    v_dot2_f32_bf16 v31, v93, v13, v31
    v_dot2_f32_bf16 v31, v94, v14, v31
    v_dot2_f32_bf16 v31, v95, v15, v31
    buffer_load_dwordx4 v[92:95], v6, s[8:11], s71 offen nt
    s_waitcnt vmcnt(15)
    v_dot2_f32_bf16 v32, v96, v12, 0
    v_dot2_f32_bf16 v32, v97, v13, v32
    v_dot2_f32_bf16 v32, v98, v14, v32
    v_dot2_f32_bf16 v32, v99, v15, v32
    buffer_load_dwordx4 v[96:99], v6, s[8:11], s72 offen nt
    s_waitcnt vmcnt(15)
    v_dot2_f32_bf16 v33, v100, v12, 0
    v_dot2_f32_bf16 v33, v101, v13, v33
    v_dot2_f32_bf16 v33, v102, v14, v33
    v_dot2_f32_bf16 v33, v103, v15, v33
    buffer_load_dwordx4 v[100:103], v6, s[8:11], s73 offen nt
    s_waitcnt vmcnt(15)
    v_dot2_f32_bf16 v34, v104, v12, 0
    v_dot2_f32_bf16 v34, v105, v13, v34
    v_dot2_f32_bf16 v34, v106, v14, v34
    v_dot2_f32_bf16 v34, v107, v15, v34
    buffer_load_dwordx4 v[104:107], v6, s[8:11], s74 offen nt
    s_waitcnt vmcnt(15)
    v_dot2_f32_bf16 v35, v108, v12, 0
    v_dot2_f32_bf16 v35, v109, v13, v35
    v_dot2_f32_bf16 v35, v110, v14, v35
    v_dot2_f32_bf16 v35, v111, v15, v35
    buffer_load_dwordx4 v[108:111], v6, s[8:11], s75 offen nt
    s_waitcnt vmcnt(15)
    v_dot2_f32_bf16 v36, v112, v12, 0
    v_dot2_f32_bf16 v36, v113, v13, v36
    v_dot2_f32_bf16 v36, v114, v14, v36
    v_dot2_f32_bf16 v36, v115, v15, v36
    buffer_load_dwordx4 v[112:115], v6, s[8:11], s76 offen nt
    s_waitcnt vmcnt(15)
    v_dot2_f32_bf16 v37, v116, v12, 0
    v_dot2_f32_bf16 v37, v117, v13, v37
    v_dot2_f32_bf16 v37, v118, v14, v37
    v_dot2_f32_bf16 v37, v119, v15, v37
    buffer_load_dwordx4 v[116:119], v6, s[8:11], s77 offen nt
    s_waitcnt vmcnt(15)
    v_dot2_f32_bf16 v38, v120, v12, 0
    v_dot2_f32_bf16 v38, v121, v13, v38
    v_dot2_f32_bf16 v38, v122, v14, v38
    v_dot2_f32_bf16 v38, v123, v15, v38
    buffer_load_dwordx4 v[120:123], v6, s[8:11], s78 offen nt
    v_mov_b32 v10, s53
    ds_max_u32 v3, v10 offset:8
    s_waitcnt vmcnt(15)
    v_dot2_f32_bf16 v39, v124, v12, 0
    v_dot2_f32_bf16 v39, v125, v13, v39
    v_dot2_f32_bf16 v39, v126, v14, v39
    v_dot2_f32_bf16 v39, v127, v15, v39
    buffer_load_dwordx4 v[124:127], v6, s[8:11], s79 offen nt
    v_add_f32_dpp v24, v24, v24 row_ror:8 row_mask:0xf bank_mask:0x3
    v_add_f32_dpp v25, v25, v25 row_ror:8 row_mask:0xf bank_mask:0x3
    v_add_f32_dpp v26, v26, v26 row_ror:8 row_mask:0xf bank_mask:0x3
    v_add_f32_dpp v27, v27, v27 row_ror:8 row_mask:0xf bank_mask:0x3
    v_add_f32_dpp v28, v28, v28 row_ror:8 row_mask:0xf bank_mask:0x3
    v_add_f32_dpp v29, v29, v29 row_ror:8 row_mask:0xf bank_mask:0x3
    v_add_f32_dpp v30, v30, v30 row_ror:8 row_mask:0xf bank_mask:0x3
    v_add_f32_dpp v31, v31, v31 row_ror:8 row_mask:0xf bank_mask:0x3
    v_add_f32_dpp v24, v32, v32 row_ror:8 row_mask:0xf bank_mask:0xc
    v_add_f32_dpp v25, v33, v33 row_ror:8 row_mask:0xf bank_mask:0xc
    v_add_f32_dpp v26, v34, v34 row_ror:8 row_mask:0xf bank_mask:0xc
    v_add_f32_dpp v27, v35, v35 row_ror:8 row_mask:0xf bank_mask:0xc
    v_add_f32_dpp v28, v36, v36 row_ror:8 row_mask:0xf bank_mask:0xc
    v_add_f32_dpp v29, v37, v37 row_ror:8 row_mask:0xf bank_mask:0xc
    v_add_f32_dpp v30, v38, v38 row_ror:8 row_mask:0xf bank_mask:0xc
    v_add_f32_dpp v31, v39, v39 row_ror:8 row_mask:0xf bank_mask:0xc
    v_add_f32_dpp v24, v24, v24 row_shl:4 row_mask:0xf bank_mask:0x5
    v_add_f32_dpp v25, v25, v25 row_shl:4 row_mask:0xf bank_mask:0x5
    v_add_f32_dpp v26, v26, v26 row_shl:4 row_mask:0xf bank_mask:0x5
    v_add_f32_dpp v27, v27, v27 row_shl:4 row_mask:0xf bank_mask:0x5
    v_add_f32_dpp v24, v28, v28 row_shr:4 row_mask:0xf bank_mask:0xa
    v_add_f32_dpp v25, v29, v29 row_shr:4 row_mask:0xf bank_mask:0xa
    v_add_f32_dpp v26, v30, v30 row_shr:4 row_mask:0xf bank_mask:0xa
    v_add_f32_dpp v27, v31, v31 row_shr:4 row_mask:0xf bank_mask:0xa
    v_add_f32_dpp v24, v24, v24 quad_perm:[2,3,0,1] row_mask:0xf bank_mask:0xf
    v_add_f32_dpp v25, v25, v25 quad_perm:[2,3,0,1] row_mask:0xf bank_mask:0xf
    v_add_f32_dpp v26, v26, v26 quad_perm:[2,3,0,1] row_mask:0xf bank_mask:0xf
    v_add_f32_dpp v27, v27, v27 quad_perm:[2,3,0,1] row_mask:0xf bank_mask:0xf
    v_cndmask_b32 v24, v24, v26, s[46:47]
    v_cndmask_b32 v25, v25, v27, s[46:47]
    s_nop 0
    v_add_f32_dpp v24, v24, v24 quad_perm:[1,0,3,2] row_mask:0xf bank_mask:0xf
    v_add_f32_dpp v25, v25, v25 quad_perm:[1,0,3,2] row_mask:0xf bank_mask:0xf
    v_cndmask_b32 v58, v24, v25, s[44:45]
    v_cvt_pk_bf16_f32 v58, 0, v58
    v_mul_f32 v58, s48, v58
    v_cvt_pk_bf16_f32 v58, 0, v58
    v_mul_f32 v55, s49, v58
    s_cmp_lt_u32 s53, 16
    s_cbranch_scc1 L_s_k
    v_max3_f32 v56, v40, v41, v42
    v_max3_f32 v56, v56, v43, v44
    v_max3_f32 v56, v56, v45, v46
    v_max3_f32 v56, v56, v47, v48
    v_max3_f32 v56, v56, v49, v50
    v_max3_f32 v56, v56, v51, v52
    v_max3_f32 v56, v56, v53, v54
    v_max_f32 v56, v56, v55
    s_nop 1
    v_max_f32_dpp v56, v56, v56 row_ror:8 row_mask:0xf bank_mask:0xf
    s_nop 1
    v_max_f32_dpp v56, v56, v56 row_ror:4 row_mask:0xf bank_mask:0xf
    s_nop 1
    v_max_f32_dpp v56, v56, v56 row_ror:2 row_mask:0xf bank_mask:0xf
    s_nop 1
    v_max_f32_dpp v56, v56, v56 row_ror:1 row_mask:0xf bank_mask:0xf
    v_mov_b32 v61, v56
    s_nop 1
    v_permlane16_swap_b32 v56, v61
    s_nop 1
    v_max_f32 v56, v56, v61
    v_mov_b32 v61, v56
    s_nop 1
    v_permlane32_swap_b32 v56, v61
    s_nop 1
    v_max_f32 v56, v56, v61
    v_sub_f32 v24, v40, v56
    v_sub_f32 v25, v41, v56
    v_sub_f32 v26, v42, v56
    v_sub_f32 v27, v43, v56
    v_sub_f32 v28, v44, v56
    v_sub_f32 v29, v45, v56
    v_sub_f32 v30, v46, v56
    v_sub_f32 v31, v47, v56
    v_sub_f32 v32, v48, v56
    v_sub_f32 v33, v49, v56
    v_sub_f32 v34, v50, v56
    v_sub_f32 v35, v51, v56
    v_sub_f32 v36, v52, v56
    v_sub_f32 v37, v53, v56
    v_sub_f32 v38, v54, v56
    v_sub_f32 v39, v55, v56
    v_exp_f32 v40, v24
    v_exp_f32 v41, v25
    v_exp_f32 v42, v26
    v_exp_f32 v43, v27
    v_exp_f32 v44, v28
    v_exp_f32 v45, v29
    v_exp_f32 v46, v30
    v_exp_f32 v47, v31
    v_exp_f32 v48, v32
    v_exp_f32 v49, v33
    v_exp_f32 v50, v34
    v_exp_f32 v51, v35
    v_exp_f32 v52, v36
    v_exp_f32 v53, v37
    v_exp_f32 v54, v38
    v_exp_f32 v55, v39
    s_nop 0
    v_cvt_pk_bf16_f32 v40, 0, v40
    v_cvt_pk_bf16_f32 v41, 0, v41
    v_cvt_pk_bf16_f32 v42, 0, v42
    v_cvt_pk_bf16_f32 v43, 0, v43
    v_cvt_pk_bf16_f32 v44, 0, v44
    v_cvt_pk_bf16_f32 v45, 0, v45
    v_cvt_pk_bf16_f32 v46, 0, v46
    v_cvt_pk_bf16_f32 v47, 0, v47
    v_cvt_pk_bf16_f32 v48, 0, v48
    v_cvt_pk_bf16_f32 v49, 0, v49
    v_cvt_pk_bf16_f32 v50, 0, v50
    v_cvt_pk_bf16_f32 v51, 0, v51
    v_cvt_pk_bf16_f32 v52, 0, v52
    v_cvt_pk_bf16_f32 v53, 0, v53
    v_cvt_pk_bf16_f32 v54, 0, v54
    v_cvt_pk_bf16_f32 v55, 0, v55
    v_add_f32 v57, v40, v41
    v_add_f32 v59, v42, v43
    v_add_f32 v57, v57, v44
    v_add_f32 v59, v59, v45
    v_add_f32 v57, v57, v46
    v_add_f32 v59, v59, v47
    v_add_f32 v57, v57, v48
    v_add_f32 v59, v59, v49
    v_add_f32 v57, v57, v50
    v_add_f32 v59, v59, v51
    v_add_f32 v57, v57, v52
    v_add_f32 v59, v59, v53
    v_add_f32 v57, v57, v54
    v_add_f32 v59, v59, v55
    v_add_f32 v57, v57, v59
    s_nop 1
    v_add_f32_dpp v57, v57, v57 row_ror:8 row_mask:0xf bank_mask:0xf
    s_nop 1
    v_add_f32_dpp v57, v57, v57 row_ror:4 row_mask:0xf bank_mask:0xf
    s_nop 1
    v_add_f32_dpp v57, v57, v57 row_ror:2 row_mask:0xf bank_mask:0xf
    s_nop 1
    v_add_f32_dpp v57, v57, v57 row_ror:1 row_mask:0xf bank_mask:0xf
    v_mov_b32 v61, v57
    s_nop 1
    v_permlane16_swap_b32 v57, v61
    s_nop 1
    v_add_f32 v57, v57, v61
    v_mov_b32 v61, v57
    s_nop 1
    v_permlane32_swap_b32 v57, v61
    s_nop 1
    v_add_f32 v57, v57, v61
    s_lshl_b32 s6, s3, 3
    s_add_u32 s6, s6, 154112
    v_mov_b32 v10, s6
    s_mov_b64 exec, 1
    ds_write_b64 v10, v[56:57]
    s_mov_b64 exec, -1
L_s_v:
    s_add_u32 s52, s52, 65536
    s_and_b32 s52, s52, 0xf0000
    s_cmp_ge_u32 s53, 31
    s_cselect_b32 s6, 0x20000000, s52
    v_add_u32 v6, s6, v5
Lfc_55:
    ds_read_b32 v7, v3 offset:24
    s_waitcnt lgkmcnt(0)
    v_readfirstlane_b32 s7, v7
    s_nop 0
    s_add_u32 s7, s7, s53
    s_cmp_le_u32 s7, 255
    s_cbranch_scc1 Lfg_56
    s_sleep 4
    s_branch Lfc_55
Lfg_56:
    s_add_u32 s53, s53, 1
    v_lshrrev_b32 v60, 16, v40
    v_mov_b32 v58, v40
    v_mov_b32 v40, v41
    v_mov_b32 v41, v42
    v_mov_b32 v42, v43
    v_mov_b32 v43, v44
    v_mov_b32 v44, v45
    v_mov_b32 v45, v46
    v_mov_b32 v46, v47
    v_mov_b32 v47, v48
    v_mov_b32 v48, v49
    v_mov_b32 v49, v50
    v_mov_b32 v50, v51
    v_mov_b32 v51, v52
    v_mov_b32 v52, v53
    v_mov_b32 v53, v54
    v_mov_b32 v54, v55
    s_waitcnt vmcnt(15)
    v_dot2c_f32_bf16_dpp v16, v60, v64 row_newbcast:0 row_mask:0xf bank_mask:0xf
    v_dot2c_f32_bf16_dpp v17, v58, v64 row_newbcast:0 row_mask:0xf bank_mask:0xf
    v_dot2c_f32_bf16_dpp v18, v60, v65 row_newbcast:0 row_mask:0xf bank_mask:0xf
    v_dot2c_f32_bf16_dpp v19, v58, v65 row_newbcast:0 row_mask:0xf bank_mask:0xf
    v_dot2c_f32_bf16_dpp v20, v60, v66 row_newbcast:0 row_mask:0xf bank_mask:0xf
    v_dot2c_f32_bf16_dpp v21, v58, v66 row_newbcast:0 row_mask:0xf bank_mask:0xf
    v_dot2c_f32_bf16_dpp v22, v60, v67 row_newbcast:0 row_mask:0xf bank_mask:0xf
    v_dot2c_f32_bf16_dpp v23, v58, v67 row_newbcast:0 row_mask:0xf bank_mask:0xf
    buffer_load_dwordx4 v[64:67], v6, s[8:11], s64 offen nt
    s_waitcnt vmcnt(15)
    v_dot2c_f32_bf16_dpp v16, v60, v68 row_newbcast:1 row_mask:0xf bank_mask:0xf
    v_dot2c_f32_bf16_dpp v17, v58, v68 row_newbcast:1 row_mask:0xf bank_mask:0xf
    v_dot2c_f32_bf16_dpp v18, v60, v69 row_newbcast:1 row_mask:0xf bank_mask:0xf
    v_dot2c_f32_bf16_dpp v19, v58, v69 row_newbcast:1 row_mask:0xf bank_mask:0xf
    v_dot2c_f32_bf16_dpp v20, v60, v70 row_newbcast:1 row_mask:0xf bank_mask:0xf
    v_dot2c_f32_bf16_dpp v21, v58, v70 row_newbcast:1 row_mask:0xf bank_mask:0xf
    v_dot2c_f32_bf16_dpp v22, v60, v71 row_newbcast:1 row_mask:0xf bank_mask:0xf
    v_dot2c_f32_bf16_dpp v23, v58, v71 row_newbcast:1 row_mask:0xf bank_mask:0xf
    buffer_load_dwordx4 v[68:71], v6, s[8:11], s65 offen nt
    s_waitcnt vmcnt(15)
    v_dot2c_f32_bf16_dpp v16, v60, v72 row_newbcast:2 row_mask:0xf bank_mask:0xf
    v_dot2c_f32_bf16_dpp v17, v58, v72 row_newbcast:2 row_mask:0xf bank_mask:0xf
    v_dot2c_f32_bf16_dpp v18, v60, v73 row_newbcast:2 row_mask:0xf bank_mask:0xf
    v_dot2c_f32_bf16_dpp v19, v58, v73 row_newbcast:2 row_mask:0xf bank_mask:0xf
    v_dot2c_f32_bf16_dpp v20, v60, v74 row_newbcast:2 row_mask:0xf bank_mask:0xf
    v_dot2c_f32_bf16_dpp v21, v58, v74 row_newbcast:2 row_mask:0xf bank_mask:0xf
    v_dot2c_f32_bf16_dpp v22, v60, v75 row_newbcast:2 row_mask:0xf bank_mask:0xf
    v_dot2c_f32_bf16_dpp v23, v58, v75 row_newbcast:2 row_mask:0xf bank_mask:0xf
    buffer_load_dwordx4 v[72:75], v6, s[8:11], s66 offen nt
    s_waitcnt vmcnt(15)
    v_dot2c_f32_bf16_dpp v16, v60, v76 row_newbcast:3 row_mask:0xf bank_mask:0xf
    v_dot2c_f32_bf16_dpp v17, v58, v76 row_newbcast:3 row_mask:0xf bank_mask:0xf
    v_dot2c_f32_bf16_dpp v18, v60, v77 row_newbcast:3 row_mask:0xf bank_mask:0xf
    v_dot2c_f32_bf16_dpp v19, v58, v77 row_newbcast:3 row_mask:0xf bank_mask:0xf
    v_dot2c_f32_bf16_dpp v20, v60, v78 row_newbcast:3 row_mask:0xf bank_mask:0xf
    v_dot2c_f32_bf16_dpp v21, v58, v78 row_newbcast:3 row_mask:0xf bank_mask:0xf
    v_dot2c_f32_bf16_dpp v22, v60, v79 row_newbcast:3 row_mask:0xf bank_mask:0xf
    v_dot2c_f32_bf16_dpp v23, v58, v79 row_newbcast:3 row_mask:0xf bank_mask:0xf
    buffer_load_dwordx4 v[76:79], v6, s[8:11], s67 offen nt
    s_waitcnt vmcnt(15)
    v_dot2c_f32_bf16_dpp v16, v60, v80 row_newbcast:4 row_mask:0xf bank_mask:0xf
    v_dot2c_f32_bf16_dpp v17, v58, v80 row_newbcast:4 row_mask:0xf bank_mask:0xf
    v_dot2c_f32_bf16_dpp v18, v60, v81 row_newbcast:4 row_mask:0xf bank_mask:0xf
    v_dot2c_f32_bf16_dpp v19, v58, v81 row_newbcast:4 row_mask:0xf bank_mask:0xf
    v_dot2c_f32_bf16_dpp v20, v60, v82 row_newbcast:4 row_mask:0xf bank_mask:0xf
    v_dot2c_f32_bf16_dpp v21, v58, v82 row_newbcast:4 row_mask:0xf bank_mask:0xf
    v_dot2c_f32_bf16_dpp v22, v60, v83 row_newbcast:4 row_mask:0xf bank_mask:0xf
    v_dot2c_f32_bf16_dpp v23, v58, v83 row_newbcast:4 row_mask:0xf bank_mask:0xf
    buffer_load_dwordx4 v[80:83], v6, s[8:11], s68 offen nt
    s_waitcnt vmcnt(15)
    v_dot2c_f32_bf16_dpp v16, v60, v84 row_newbcast:5 row_mask:0xf bank_mask:0xf
    v_dot2c_f32_bf16_dpp v17, v58, v84 row_newbcast:5 row_mask:0xf bank_mask:0xf
    v_dot2c_f32_bf16_dpp v18, v60, v85 row_newbcast:5 row_mask:0xf bank_mask:0xf
    v_dot2c_f32_bf16_dpp v19, v58, v85 row_newbcast:5 row_mask:0xf bank_mask:0xf
    v_dot2c_f32_bf16_dpp v20, v60, v86 row_newbcast:5 row_mask:0xf bank_mask:0xf
    v_dot2c_f32_bf16_dpp v21, v58, v86 row_newbcast:5 row_mask:0xf bank_mask:0xf
    v_dot2c_f32_bf16_dpp v22, v60, v87 row_newbcast:5 row_mask:0xf bank_mask:0xf
    v_dot2c_f32_bf16_dpp v23, v58, v87 row_newbcast:5 row_mask:0xf bank_mask:0xf
    buffer_load_dwordx4 v[84:87], v6, s[8:11], s69 offen nt
    s_waitcnt vmcnt(15)
    v_dot2c_f32_bf16_dpp v16, v60, v88 row_newbcast:6 row_mask:0xf bank_mask:0xf
    v_dot2c_f32_bf16_dpp v17, v58, v88 row_newbcast:6 row_mask:0xf bank_mask:0xf
    v_dot2c_f32_bf16_dpp v18, v60, v89 row_newbcast:6 row_mask:0xf bank_mask:0xf
    v_dot2c_f32_bf16_dpp v19, v58, v89 row_newbcast:6 row_mask:0xf bank_mask:0xf
    v_dot2c_f32_bf16_dpp v20, v60, v90 row_newbcast:6 row_mask:0xf bank_mask:0xf
    v_dot2c_f32_bf16_dpp v21, v58, v90 row_newbcast:6 row_mask:0xf bank_mask:0xf
    v_dot2c_f32_bf16_dpp v22, v60, v91 row_newbcast:6 row_mask:0xf bank_mask:0xf
    v_dot2c_f32_bf16_dpp v23, v58, v91 row_newbcast:6 row_mask:0xf bank_mask:0xf
    buffer_load_dwordx4 v[88:91], v6, s[8:11], s70 offen nt
    s_waitcnt vmcnt(15)
    v_dot2c_f32_bf16_dpp v16, v60, v92 row_newbcast:7 row_mask:0xf bank_mask:0xf
    v_dot2c_f32_bf16_dpp v17, v58, v92 row_newbcast:7 row_mask:0xf bank_mask:0xf
    v_dot2c_f32_bf16_dpp v18, v60, v93 row_newbcast:7 row_mask:0xf bank_mask:0xf
    v_dot2c_f32_bf16_dpp v19, v58, v93 row_newbcast:7 row_mask:0xf bank_mask:0xf
    v_dot2c_f32_bf16_dpp v20, v60, v94 row_newbcast:7 row_mask:0xf bank_mask:0xf
    v_dot2c_f32_bf16_dpp v21, v58, v94 row_newbcast:7 row_mask:0xf bank_mask:0xf
    v_dot2c_f32_bf16_dpp v22, v60, v95 row_newbcast:7 row_mask:0xf bank_mask:0xf
    v_dot2c_f32_bf16_dpp v23, v58, v95 row_newbcast:7 row_mask:0xf bank_mask:0xf
    buffer_load_dwordx4 v[92:95], v6, s[8:11], s71 offen nt
    s_waitcnt vmcnt(15)
    v_dot2c_f32_bf16_dpp v16, v60, v96 row_newbcast:8 row_mask:0xf bank_mask:0xf
    v_dot2c_f32_bf16_dpp v17, v58, v96 row_newbcast:8 row_mask:0xf bank_mask:0xf
    v_dot2c_f32_bf16_dpp v18, v60, v97 row_newbcast:8 row_mask:0xf bank_mask:0xf
    v_dot2c_f32_bf16_dpp v19, v58, v97 row_newbcast:8 row_mask:0xf bank_mask:0xf
    v_dot2c_f32_bf16_dpp v20, v60, v98 row_newbcast:8 row_mask:0xf bank_mask:0xf
    v_dot2c_f32_bf16_dpp v21, v58, v98 row_newbcast:8 row_mask:0xf bank_mask:0xf
    v_dot2c_f32_bf16_dpp v22, v60, v99 row_newbcast:8 row_mask:0xf bank_mask:0xf
    v_dot2c_f32_bf16_dpp v23, v58, v99 row_newbcast:8 row_mask:0xf bank_mask:0xf
    buffer_load_dwordx4 v[96:99], v6, s[8:11], s72 offen nt
    s_waitcnt vmcnt(15)
    v_dot2c_f32_bf16_dpp v16, v60, v100 row_newbcast:9 row_mask:0xf bank_mask:0xf
    v_dot2c_f32_bf16_dpp v17, v58, v100 row_newbcast:9 row_mask:0xf bank_mask:0xf
    v_dot2c_f32_bf16_dpp v18, v60, v101 row_newbcast:9 row_mask:0xf bank_mask:0xf
    v_dot2c_f32_bf16_dpp v19, v58, v101 row_newbcast:9 row_mask:0xf bank_mask:0xf
    v_dot2c_f32_bf16_dpp v20, v60, v102 row_newbcast:9 row_mask:0xf bank_mask:0xf
    v_dot2c_f32_bf16_dpp v21, v58, v102 row_newbcast:9 row_mask:0xf bank_mask:0xf
    v_dot2c_f32_bf16_dpp v22, v60, v103 row_newbcast:9 row_mask:0xf bank_mask:0xf
    v_dot2c_f32_bf16_dpp v23, v58, v103 row_newbcast:9 row_mask:0xf bank_mask:0xf
    buffer_load_dwordx4 v[100:103], v6, s[8:11], s73 offen nt
    s_waitcnt vmcnt(15)
    v_dot2c_f32_bf16_dpp v16, v60, v104 row_newbcast:10 row_mask:0xf bank_mask:0xf
    v_dot2c_f32_bf16_dpp v17, v58, v104 row_newbcast:10 row_mask:0xf bank_mask:0xf
    v_dot2c_f32_bf16_dpp v18, v60, v105 row_newbcast:10 row_mask:0xf bank_mask:0xf
    v_dot2c_f32_bf16_dpp v19, v58, v105 row_newbcast:10 row_mask:0xf bank_mask:0xf
    v_dot2c_f32_bf16_dpp v20, v60, v106 row_newbcast:10 row_mask:0xf bank_mask:0xf
    v_dot2c_f32_bf16_dpp v21, v58, v106 row_newbcast:10 row_mask:0xf bank_mask:0xf
    v_dot2c_f32_bf16_dpp v22, v60, v107 row_newbcast:10 row_mask:0xf bank_mask:0xf
    v_dot2c_f32_bf16_dpp v23, v58, v107 row_newbcast:10 row_mask:0xf bank_mask:0xf
    buffer_load_dwordx4 v[104:107], v6, s[8:11], s74 offen nt
    s_waitcnt vmcnt(15)
    v_dot2c_f32_bf16_dpp v16, v60, v108 row_newbcast:11 row_mask:0xf bank_mask:0xf
    v_dot2c_f32_bf16_dpp v17, v58, v108 row_newbcast:11 row_mask:0xf bank_mask:0xf
    v_dot2c_f32_bf16_dpp v18, v60, v109 row_newbcast:11 row_mask:0xf bank_mask:0xf
    v_dot2c_f32_bf16_dpp v19, v58, v109 row_newbcast:11 row_mask:0xf bank_mask:0xf
    v_dot2c_f32_bf16_dpp v20, v60, v110 row_newbcast:11 row_mask:0xf bank_mask:0xf
    v_dot2c_f32_bf16_dpp v21, v58, v110 row_newbcast:11 row_mask:0xf bank_mask:0xf
    v_dot2c_f32_bf16_dpp v22, v60, v111 row_newbcast:11 row_mask:0xf bank_mask:0xf
    v_dot2c_f32_bf16_dpp v23, v58, v111 row_newbcast:11 row_mask:0xf bank_mask:0xf
    buffer_load_dwordx4 v[108:111], v6, s[8:11], s75 offen nt
    s_waitcnt vmcnt(15)
    v_dot2c_f32_bf16_dpp v16, v60, v112 row_newbcast:12 row_mask:0xf bank_mask:0xf
    v_dot2c_f32_bf16_dpp v17, v58, v112 row_newbcast:12 row_mask:0xf bank_mask:0xf
    v_dot2c_f32_bf16_dpp v18, v60, v113 row_newbcast:12 row_mask:0xf bank_mask:0xf
    v_dot2c_f32_bf16_dpp v19, v58, v113 row_newbcast:12 row_mask:0xf bank_mask:0xf
    v_dot2c_f32_bf16_dpp v20, v60, v114 row_newbcast:12 row_mask:0xf bank_mask:0xf
    v_dot2c_f32_bf16_dpp v21, v58, v114 row_newbcast:12 row_mask:0xf bank_mask:0xf
    v_dot2c_f32_bf16_dpp v22, v60, v115 row_newbcast:12 row_mask:0xf bank_mask:0xf
    v_dot2c_f32_bf16_dpp v23, v58, v115 row_newbcast:12 row_mask:0xf bank_mask:0xf
    buffer_load_dwordx4 v[112:115], v6, s[8:11], s76 offen nt
    s_waitcnt vmcnt(15)
    v_dot2c_f32_bf16_dpp v16, v60, v116 row_newbcast:13 row_mask:0xf bank_mask:0xf
    v_dot2c_f32_bf16_dpp v17, v58, v116 row_newbcast:13 row_mask:0xf bank_mask:0xf
    v_dot2c_f32_bf16_dpp v18, v60, v117 row_newbcast:13 row_mask:0xf bank_mask:0xf
    v_dot2c_f32_bf16_dpp v19, v58, v117 row_newbcast:13 row_mask:0xf bank_mask:0xf
    v_dot2c_f32_bf16_dpp v20, v60, v118 row_newbcast:13 row_mask:0xf bank_mask:0xf
    v_dot2c_f32_bf16_dpp v21, v58, v118 row_newbcast:13 row_mask:0xf bank_mask:0xf
    v_dot2c_f32_bf16_dpp v22, v60, v119 row_newbcast:13 row_mask:0xf bank_mask:0xf
    v_dot2c_f32_bf16_dpp v23, v58, v119 row_newbcast:13 row_mask:0xf bank_mask:0xf
    buffer_load_dwordx4 v[116:119], v6, s[8:11], s77 offen nt
    s_waitcnt vmcnt(15)
    v_dot2c_f32_bf16_dpp v16, v60, v120 row_newbcast:14 row_mask:0xf bank_mask:0xf
    v_dot2c_f32_bf16_dpp v17, v58, v120 row_newbcast:14 row_mask:0xf bank_mask:0xf
    v_dot2c_f32_bf16_dpp v18, v60, v121 row_newbcast:14 row_mask:0xf bank_mask:0xf
    v_dot2c_f32_bf16_dpp v19, v58, v121 row_newbcast:14 row_mask:0xf bank_mask:0xf
    v_dot2c_f32_bf16_dpp v20, v60, v122 row_newbcast:14 row_mask:0xf bank_mask:0xf
    v_dot2c_f32_bf16_dpp v21, v58, v122 row_newbcast:14 row_mask:0xf bank_mask:0xf
    v_dot2c_f32_bf16_dpp v22, v60, v123 row_newbcast:14 row_mask:0xf bank_mask:0xf
    v_dot2c_f32_bf16_dpp v23, v58, v123 row_newbcast:14 row_mask:0xf bank_mask:0xf
    buffer_load_dwordx4 v[120:123], v6, s[8:11], s78 offen nt
    v_mov_b32 v10, s53
    ds_max_u32 v3, v10 offset:8
    s_waitcnt vmcnt(15)
    v_dot2c_f32_bf16_dpp v16, v60, v124 row_newbcast:15 row_mask:0xf bank_mask:0xf
    v_dot2c_f32_bf16_dpp v17, v58, v124 row_newbcast:15 row_mask:0xf bank_mask:0xf
    v_dot2c_f32_bf16_dpp v18, v60, v125 row_newbcast:15 row_mask:0xf bank_mask:0xf
    v_dot2c_f32_bf16_dpp v19, v58, v125 row_newbcast:15 row_mask:0xf bank_mask:0xf
    v_dot2c_f32_bf16_dpp v20, v60, v126 row_newbcast:15 row_mask:0xf bank_mask:0xf
    v_dot2c_f32_bf16_dpp v21, v58, v126 row_newbcast:15 row_mask:0xf bank_mask:0xf
    v_dot2c_f32_bf16_dpp v22, v60, v127 row_newbcast:15 row_mask:0xf bank_mask:0xf
    v_dot2c_f32_bf16_dpp v23, v58, v127 row_newbcast:15 row_mask:0xf bank_mask:0xf
    buffer_load_dwordx4 v[124:127], v6, s[8:11], s79 offen nt
    s_cmp_lt_u32 s53, 31
    s_cbranch_scc1 L_s_v
    v_lshrrev_b32 v60, 16, v40
    v_mov_b32 v58, v40
    s_nop 1
    s_waitcnt vmcnt(15)
    v_dot2c_f32_bf16_dpp v16, v60, v64 row_newbcast:0 row_mask:0xf bank_mask:0xf
    v_dot2c_f32_bf16_dpp v17, v58, v64 row_newbcast:0 row_mask:0xf bank_mask:0xf
    v_dot2c_f32_bf16_dpp v18, v60, v65 row_newbcast:0 row_mask:0xf bank_mask:0xf
    v_dot2c_f32_bf16_dpp v19, v58, v65 row_newbcast:0 row_mask:0xf bank_mask:0xf
    v_dot2c_f32_bf16_dpp v20, v60, v66 row_newbcast:0 row_mask:0xf bank_mask:0xf
    v_dot2c_f32_bf16_dpp v21, v58, v66 row_newbcast:0 row_mask:0xf bank_mask:0xf
    v_dot2c_f32_bf16_dpp v22, v60, v67 row_newbcast:0 row_mask:0xf bank_mask:0xf
    v_dot2c_f32_bf16_dpp v23, v58, v67 row_newbcast:0 row_mask:0xf bank_mask:0xf
    s_waitcnt vmcnt(14)
    v_dot2c_f32_bf16_dpp v16, v60, v68 row_newbcast:1 row_mask:0xf bank_mask:0xf
    v_dot2c_f32_bf16_dpp v17, v58, v68 row_newbcast:1 row_mask:0xf bank_mask:0xf
    v_dot2c_f32_bf16_dpp v18, v60, v69 row_newbcast:1 row_mask:0xf bank_mask:0xf
    v_dot2c_f32_bf16_dpp v19, v58, v69 row_newbcast:1 row_mask:0xf bank_mask:0xf
    v_dot2c_f32_bf16_dpp v20, v60, v70 row_newbcast:1 row_mask:0xf bank_mask:0xf
    v_dot2c_f32_bf16_dpp v21, v58, v70 row_newbcast:1 row_mask:0xf bank_mask:0xf
    v_dot2c_f32_bf16_dpp v22, v60, v71 row_newbcast:1 row_mask:0xf bank_mask:0xf
    v_dot2c_f32_bf16_dpp v23, v58, v71 row_newbcast:1 row_mask:0xf bank_mask:0xf
    s_waitcnt vmcnt(13)
    v_dot2c_f32_bf16_dpp v16, v60, v72 row_newbcast:2 row_mask:0xf bank_mask:0xf
    v_dot2c_f32_bf16_dpp v17, v58, v72 row_newbcast:2 row_mask:0xf bank_mask:0xf
    v_dot2c_f32_bf16_dpp v18, v60, v73 row_newbcast:2 row_mask:0xf bank_mask:0xf
    v_dot2c_f32_bf16_dpp v19, v58, v73 row_newbcast:2 row_mask:0xf bank_mask:0xf
    v_dot2c_f32_bf16_dpp v20, v60, v74 row_newbcast:2 row_mask:0xf bank_mask:0xf
    v_dot2c_f32_bf16_dpp v21, v58, v74 row_newbcast:2 row_mask:0xf bank_mask:0xf
    v_dot2c_f32_bf16_dpp v22, v60, v75 row_newbcast:2 row_mask:0xf bank_mask:0xf
    v_dot2c_f32_bf16_dpp v23, v58, v75 row_newbcast:2 row_mask:0xf bank_mask:0xf
    s_waitcnt vmcnt(12)
    v_dot2c_f32_bf16_dpp v16, v60, v76 row_newbcast:3 row_mask:0xf bank_mask:0xf
    v_dot2c_f32_bf16_dpp v17, v58, v76 row_newbcast:3 row_mask:0xf bank_mask:0xf
    v_dot2c_f32_bf16_dpp v18, v60, v77 row_newbcast:3 row_mask:0xf bank_mask:0xf
    v_dot2c_f32_bf16_dpp v19, v58, v77 row_newbcast:3 row_mask:0xf bank_mask:0xf
    v_dot2c_f32_bf16_dpp v20, v60, v78 row_newbcast:3 row_mask:0xf bank_mask:0xf
    v_dot2c_f32_bf16_dpp v21, v58, v78 row_newbcast:3 row_mask:0xf bank_mask:0xf
    v_dot2c_f32_bf16_dpp v22, v60, v79 row_newbcast:3 row_mask:0xf bank_mask:0xf
    v_dot2c_f32_bf16_dpp v23, v58, v79 row_newbcast:3 row_mask:0xf bank_mask:0xf
    s_waitcnt vmcnt(11)
    v_dot2c_f32_bf16_dpp v16, v60, v80 row_newbcast:4 row_mask:0xf bank_mask:0xf
    v_dot2c_f32_bf16_dpp v17, v58, v80 row_newbcast:4 row_mask:0xf bank_mask:0xf
    v_dot2c_f32_bf16_dpp v18, v60, v81 row_newbcast:4 row_mask:0xf bank_mask:0xf
    v_dot2c_f32_bf16_dpp v19, v58, v81 row_newbcast:4 row_mask:0xf bank_mask:0xf
    v_dot2c_f32_bf16_dpp v20, v60, v82 row_newbcast:4 row_mask:0xf bank_mask:0xf
    v_dot2c_f32_bf16_dpp v21, v58, v82 row_newbcast:4 row_mask:0xf bank_mask:0xf
    v_dot2c_f32_bf16_dpp v22, v60, v83 row_newbcast:4 row_mask:0xf bank_mask:0xf
    v_dot2c_f32_bf16_dpp v23, v58, v83 row_newbcast:4 row_mask:0xf bank_mask:0xf
    s_waitcnt vmcnt(10)
    v_dot2c_f32_bf16_dpp v16, v60, v84 row_newbcast:5 row_mask:0xf bank_mask:0xf
    v_dot2c_f32_bf16_dpp v17, v58, v84 row_newbcast:5 row_mask:0xf bank_mask:0xf
    v_dot2c_f32_bf16_dpp v18, v60, v85 row_newbcast:5 row_mask:0xf bank_mask:0xf
    v_dot2c_f32_bf16_dpp v19, v58, v85 row_newbcast:5 row_mask:0xf bank_mask:0xf
    v_dot2c_f32_bf16_dpp v20, v60, v86 row_newbcast:5 row_mask:0xf bank_mask:0xf
    v_dot2c_f32_bf16_dpp v21, v58, v86 row_newbcast:5 row_mask:0xf bank_mask:0xf
    v_dot2c_f32_bf16_dpp v22, v60, v87 row_newbcast:5 row_mask:0xf bank_mask:0xf
    v_dot2c_f32_bf16_dpp v23, v58, v87 row_newbcast:5 row_mask:0xf bank_mask:0xf
    s_waitcnt vmcnt(9)
    v_dot2c_f32_bf16_dpp v16, v60, v88 row_newbcast:6 row_mask:0xf bank_mask:0xf
    v_dot2c_f32_bf16_dpp v17, v58, v88 row_newbcast:6 row_mask:0xf bank_mask:0xf
    v_dot2c_f32_bf16_dpp v18, v60, v89 row_newbcast:6 row_mask:0xf bank_mask:0xf
    v_dot2c_f32_bf16_dpp v19, v58, v89 row_newbcast:6 row_mask:0xf bank_mask:0xf
    v_dot2c_f32_bf16_dpp v20, v60, v90 row_newbcast:6 row_mask:0xf bank_mask:0xf
    v_dot2c_f32_bf16_dpp v21, v58, v90 row_newbcast:6 row_mask:0xf bank_mask:0xf
    v_dot2c_f32_bf16_dpp v22, v60, v91 row_newbcast:6 row_mask:0xf bank_mask:0xf
    v_dot2c_f32_bf16_dpp v23, v58, v91 row_newbcast:6 row_mask:0xf bank_mask:0xf
    s_waitcnt vmcnt(8)
    v_dot2c_f32_bf16_dpp v16, v60, v92 row_newbcast:7 row_mask:0xf bank_mask:0xf
    v_dot2c_f32_bf16_dpp v17, v58, v92 row_newbcast:7 row_mask:0xf bank_mask:0xf
    v_dot2c_f32_bf16_dpp v18, v60, v93 row_newbcast:7 row_mask:0xf bank_mask:0xf
    v_dot2c_f32_bf16_dpp v19, v58, v93 row_newbcast:7 row_mask:0xf bank_mask:0xf
    v_dot2c_f32_bf16_dpp v20, v60, v94 row_newbcast:7 row_mask:0xf bank_mask:0xf
    v_dot2c_f32_bf16_dpp v21, v58, v94 row_newbcast:7 row_mask:0xf bank_mask:0xf
    v_dot2c_f32_bf16_dpp v22, v60, v95 row_newbcast:7 row_mask:0xf bank_mask:0xf
    v_dot2c_f32_bf16_dpp v23, v58, v95 row_newbcast:7 row_mask:0xf bank_mask:0xf
    s_waitcnt vmcnt(7)
    v_dot2c_f32_bf16_dpp v16, v60, v96 row_newbcast:8 row_mask:0xf bank_mask:0xf
    v_dot2c_f32_bf16_dpp v17, v58, v96 row_newbcast:8 row_mask:0xf bank_mask:0xf
    v_dot2c_f32_bf16_dpp v18, v60, v97 row_newbcast:8 row_mask:0xf bank_mask:0xf
    v_dot2c_f32_bf16_dpp v19, v58, v97 row_newbcast:8 row_mask:0xf bank_mask:0xf
    v_dot2c_f32_bf16_dpp v20, v60, v98 row_newbcast:8 row_mask:0xf bank_mask:0xf
    v_dot2c_f32_bf16_dpp v21, v58, v98 row_newbcast:8 row_mask:0xf bank_mask:0xf
    v_dot2c_f32_bf16_dpp v22, v60, v99 row_newbcast:8 row_mask:0xf bank_mask:0xf
    v_dot2c_f32_bf16_dpp v23, v58, v99 row_newbcast:8 row_mask:0xf bank_mask:0xf
    s_waitcnt vmcnt(6)
    v_dot2c_f32_bf16_dpp v16, v60, v100 row_newbcast:9 row_mask:0xf bank_mask:0xf
    v_dot2c_f32_bf16_dpp v17, v58, v100 row_newbcast:9 row_mask:0xf bank_mask:0xf
    v_dot2c_f32_bf16_dpp v18, v60, v101 row_newbcast:9 row_mask:0xf bank_mask:0xf
    v_dot2c_f32_bf16_dpp v19, v58, v101 row_newbcast:9 row_mask:0xf bank_mask:0xf
    v_dot2c_f32_bf16_dpp v20, v60, v102 row_newbcast:9 row_mask:0xf bank_mask:0xf
    v_dot2c_f32_bf16_dpp v21, v58, v102 row_newbcast:9 row_mask:0xf bank_mask:0xf
    v_dot2c_f32_bf16_dpp v22, v60, v103 row_newbcast:9 row_mask:0xf bank_mask:0xf
    v_dot2c_f32_bf16_dpp v23, v58, v103 row_newbcast:9 row_mask:0xf bank_mask:0xf
    s_waitcnt vmcnt(5)
    v_dot2c_f32_bf16_dpp v16, v60, v104 row_newbcast:10 row_mask:0xf bank_mask:0xf
    v_dot2c_f32_bf16_dpp v17, v58, v104 row_newbcast:10 row_mask:0xf bank_mask:0xf
    v_dot2c_f32_bf16_dpp v18, v60, v105 row_newbcast:10 row_mask:0xf bank_mask:0xf
    v_dot2c_f32_bf16_dpp v19, v58, v105 row_newbcast:10 row_mask:0xf bank_mask:0xf
    v_dot2c_f32_bf16_dpp v20, v60, v106 row_newbcast:10 row_mask:0xf bank_mask:0xf
    v_dot2c_f32_bf16_dpp v21, v58, v106 row_newbcast:10 row_mask:0xf bank_mask:0xf
    v_dot2c_f32_bf16_dpp v22, v60, v107 row_newbcast:10 row_mask:0xf bank_mask:0xf
    v_dot2c_f32_bf16_dpp v23, v58, v107 row_newbcast:10 row_mask:0xf bank_mask:0xf
    s_waitcnt vmcnt(4)
    v_dot2c_f32_bf16_dpp v16, v60, v108 row_newbcast:11 row_mask:0xf bank_mask:0xf
    v_dot2c_f32_bf16_dpp v17, v58, v108 row_newbcast:11 row_mask:0xf bank_mask:0xf
    v_dot2c_f32_bf16_dpp v18, v60, v109 row_newbcast:11 row_mask:0xf bank_mask:0xf
    v_dot2c_f32_bf16_dpp v19, v58, v109 row_newbcast:11 row_mask:0xf bank_mask:0xf
    v_dot2c_f32_bf16_dpp v20, v60, v110 row_newbcast:11 row_mask:0xf bank_mask:0xf
    v_dot2c_f32_bf16_dpp v21, v58, v110 row_newbcast:11 row_mask:0xf bank_mask:0xf
    v_dot2c_f32_bf16_dpp v22, v60, v111 row_newbcast:11 row_mask:0xf bank_mask:0xf
    v_dot2c_f32_bf16_dpp v23, v58, v111 row_newbcast:11 row_mask:0xf bank_mask:0xf
    s_waitcnt vmcnt(3)
    v_dot2c_f32_bf16_dpp v16, v60, v112 row_newbcast:12 row_mask:0xf bank_mask:0xf
    v_dot2c_f32_bf16_dpp v17, v58, v112 row_newbcast:12 row_mask:0xf bank_mask:0xf
    v_dot2c_f32_bf16_dpp v18, v60, v113 row_newbcast:12 row_mask:0xf bank_mask:0xf
    v_dot2c_f32_bf16_dpp v19, v58, v113 row_newbcast:12 row_mask:0xf bank_mask:0xf
    v_dot2c_f32_bf16_dpp v20, v60, v114 row_newbcast:12 row_mask:0xf bank_mask:0xf
    v_dot2c_f32_bf16_dpp v21, v58, v114 row_newbcast:12 row_mask:0xf bank_mask:0xf
    v_dot2c_f32_bf16_dpp v22, v60, v115 row_newbcast:12 row_mask:0xf bank_mask:0xf
    v_dot2c_f32_bf16_dpp v23, v58, v115 row_newbcast:12 row_mask:0xf bank_mask:0xf
    s_waitcnt vmcnt(2)
    v_dot2c_f32_bf16_dpp v16, v60, v116 row_newbcast:13 row_mask:0xf bank_mask:0xf
    v_dot2c_f32_bf16_dpp v17, v58, v116 row_newbcast:13 row_mask:0xf bank_mask:0xf
    v_dot2c_f32_bf16_dpp v18, v60, v117 row_newbcast:13 row_mask:0xf bank_mask:0xf
    v_dot2c_f32_bf16_dpp v19, v58, v117 row_newbcast:13 row_mask:0xf bank_mask:0xf
    v_dot2c_f32_bf16_dpp v20, v60, v118 row_newbcast:13 row_mask:0xf bank_mask:0xf
    v_dot2c_f32_bf16_dpp v21, v58, v118 row_newbcast:13 row_mask:0xf bank_mask:0xf
    v_dot2c_f32_bf16_dpp v22, v60, v119 row_newbcast:13 row_mask:0xf bank_mask:0xf
    v_dot2c_f32_bf16_dpp v23, v58, v119 row_newbcast:13 row_mask:0xf bank_mask:0xf
    s_waitcnt vmcnt(1)
    v_dot2c_f32_bf16_dpp v16, v60, v120 row_newbcast:14 row_mask:0xf bank_mask:0xf
    v_dot2c_f32_bf16_dpp v17, v58, v120 row_newbcast:14 row_mask:0xf bank_mask:0xf
    v_dot2c_f32_bf16_dpp v18, v60, v121 row_newbcast:14 row_mask:0xf bank_mask:0xf
    v_dot2c_f32_bf16_dpp v19, v58, v121 row_newbcast:14 row_mask:0xf bank_mask:0xf
    v_dot2c_f32_bf16_dpp v20, v60, v122 row_newbcast:14 row_mask:0xf bank_mask:0xf
    v_dot2c_f32_bf16_dpp v21, v58, v122 row_newbcast:14 row_mask:0xf bank_mask:0xf
    v_dot2c_f32_bf16_dpp v22, v60, v123 row_newbcast:14 row_mask:0xf bank_mask:0xf
    v_dot2c_f32_bf16_dpp v23, v58, v123 row_newbcast:14 row_mask:0xf bank_mask:0xf
    s_waitcnt vmcnt(0)
    v_dot2c_f32_bf16_dpp v16, v60, v124 row_newbcast:15 row_mask:0xf bank_mask:0xf
    v_dot2c_f32_bf16_dpp v17, v58, v124 row_newbcast:15 row_mask:0xf bank_mask:0xf
    v_dot2c_f32_bf16_dpp v18, v60, v125 row_newbcast:15 row_mask:0xf bank_mask:0xf
    v_dot2c_f32_bf16_dpp v19, v58, v125 row_newbcast:15 row_mask:0xf bank_mask:0xf
    v_dot2c_f32_bf16_dpp v20, v60, v126 row_newbcast:15 row_mask:0xf bank_mask:0xf
    v_dot2c_f32_bf16_dpp v21, v58, v126 row_newbcast:15 row_mask:0xf bank_mask:0xf
    v_dot2c_f32_bf16_dpp v22, v60, v127 row_newbcast:15 row_mask:0xf bank_mask:0xf
    v_dot2c_f32_bf16_dpp v23, v58, v127 row_newbcast:15 row_mask:0xf bank_mask:0xf
    s_nop 2
    v_permlane32_swap_b32 v16, v20
    v_permlane32_swap_b32 v17, v21
    v_permlane32_swap_b32 v18, v22
    v_permlane32_swap_b32 v19, v23
    s_nop 1
    v_add_f32 v16, v16, v20
    v_add_f32 v17, v17, v21
    v_add_f32 v18, v18, v22
    v_add_f32 v19, v19, v23
    s_nop 1
    v_permlane16_swap_b32 v16, v18
    v_permlane16_swap_b32 v17, v19
    s_nop 1
    v_add_f32 v16, v16, v18
    v_add_f32 v17, v17, v19
    ds_write_b64 v9, v[16:17]
    s_mov_b64 exec, 1
    ds_add_u32 v3, v4 offset:16
    s_mov_b64 exec, -1
    s_waitcnt lgkmcnt(0)
L_done:
    s_endpgm
.section .rodata,"a"
.p2align 6
.amdhsa_kernel parallel_sum__mha_block_cached__glu_gated_bilinear__decode_kernel
  .amdhsa_next_free_vgpr 168
  .amdhsa_next_free_sgpr 96
  .amdhsa_accum_offset 168
  .amdhsa_group_segment_fixed_size 0
  .amdhsa_kernarg_size 96
  .amdhsa_user_sgpr_count 2
  .amdhsa_user_sgpr_kernarg_segment_ptr 1
  .amdhsa_system_sgpr_workgroup_id_x 1
  .amdhsa_float_denorm_mode_32 3
.end_amdhsa_kernel
```
